```python
import torch

def _softmax(x, axis=-1):
    return torch.softmax(x, dim=axis)
def _gelu(x):
    return torch.nn.functional.gelu(x, approximate="tanh")
def _silu(x):
    return torch.nn.functional.silu(x)
def _sigmoid(x):
    return torch.sigmoid(x)
def _layernorm(x, axis=-1, eps=1e-5):
    m = x.mean(dim=axis, keepdim=True)
    v = x.var(dim=axis, keepdim=True, unbiased=False)
    return (x - m) / torch.sqrt(v + eps)
def _scatter_add(tgt, idx, src, axis=0):
    return tgt.clone().index_add_(axis, idx, src)
def _segment_sum(src, seg, n):
    out = torch.zeros((n,) + src.shape[1:], dtype=src.dtype)
    return out.index_add_(0, seg, src)
def _pad(x, pw):
    flat = tuple(v for pair in reversed(pw) for v in pair)
    return torch.nn.functional.pad(x, flat)

kernel_name = 'sequential_preLN__sliding_block_cached__geglu_ffn__decode'

def setup_inputs():

    _w = (lambda a: (lambda t: t.to(torch.bfloat16) if t.is_floating_point() else t)(torch.as_tensor(a)))
    def _A_setup():
        B, Sq, D = 1, 1, 576
        Hq, Hkv, Sk, Dh = 32, 16, 65536, 128
        assert Hq % Hkv == 0, (Hq, Hkv)
        return {
            "x": _w((lambda *s: torch.randn(*s, dtype=torch.bfloat16) * 0.05)(B, Sq, D)),
            "k_cache": _w((lambda *s: torch.randn(*s, dtype=torch.bfloat16) * 3.2)(B, Hkv, Sk, Dh)),
            "v_cache": _w((lambda *s: torch.randn(*s, dtype=torch.bfloat16) * 0.4)(B, Hkv, Sk, Dh)),
            "wq": _w((lambda *s: torch.randn(*s, dtype=torch.bfloat16) * 3.2)(D, Hq * Dh) * (D ** -0.5)),
            "wo": _w((lambda *s: torch.randn(*s, dtype=torch.bfloat16) * 0.4)(Hq * Dh, D) * ((Hq * Dh) ** -0.5)),
        }
    _A_in = _A_setup()

    def _B_setup():
        B, S, D, F = 1, 1, 576, 4608
        return {
            "x": _w((lambda *s: torch.randn(*s, dtype=torch.bfloat16) * 0.05)(B, S, D)),
            "w_gate": _w((lambda *s: torch.randn(*s, dtype=torch.bfloat16) * 0.05)(D, F)),
            "w_up": _w((lambda *s: torch.randn(*s, dtype=torch.bfloat16) * 0.05)(D, F)),
            "w_down": _w((lambda *s: torch.randn(*s, dtype=torch.bfloat16) * 0.05)(F, D)),
        }
    _B_in = _B_setup()

    return {
        "A_x": _A_in["x"],
        "A_k_cache": _A_in["k_cache"],
        "A_v_cache": _A_in["v_cache"],
        "A_wq": _A_in["wq"],
        "A_wo": _A_in["wo"],
        "B_x": _B_in["x"],
        "B_w_gate": _B_in["w_gate"],
        "B_w_up": _B_in["w_up"],
        "B_w_down": _B_in["w_down"],
    }

def reference(A_x, A_k_cache, A_v_cache, A_wq, A_wo, B_x, B_w_gate, B_w_up, B_w_down):
    def _A_ref(x, k_cache, v_cache, wq, wo):
        B, Sq, D = x.shape
        Hq, Dh = 32, 128
        Hkv, Sk = k_cache.shape[1], k_cache.shape[2]
        W = min(4096, max(256, Sk // 4))
        rep = Hq // Hkv
        q = (lambda x, *d: x.permute(*d))((x @ wq).reshape(B, Sq, Hq, Dh), 0, 2, 1, 3)
        k = (lambda x, n, axis: torch.repeat_interleave(x, n, dim=axis))(k_cache[:, :, Sk - W:, :], rep, axis=1)
        v = (lambda x, n, axis: torch.repeat_interleave(x, n, dim=axis))(v_cache[:, :, Sk - W:, :], rep, axis=1)
        scores = torch.einsum("bhqd,bhkd->bhqk", q, k) * (Dh ** -0.5)
        p = _softmax(scores, axis=-1)
        o = torch.einsum("bhqk,bhkd->bhqd", p, v)
        return (lambda x, *d: x.permute(*d))(o, 0, 2, 1, 3).reshape(B, Sq, Hq * Dh) @ wo

    def _B_ref(x, w_gate, w_up, w_down):
        return (_gelu(x @ w_gate) * (x @ w_up)) @ w_down

    x = A_x
    h = x + _A_ref(_layernorm(x, axis=-1), A_k_cache, A_v_cache, A_wq, A_wo)
    h2 = h + _B_ref(_layernorm(h, axis=-1), B_w_gate, B_w_up, B_w_down)
    return h2
```

```asm
; @launch grid=(256,1,1) block=(640,1,1) lds=163840
.amdgcn_target "amdgcn-amd-amdhsa--gfx950"
.text
.globl sequential_preLN__sliding_block_cached__geglu_ffn__decode_kernel
.p2align 8
.type sequential_preLN__sliding_block_cached__geglu_ffn__decode_kernel,@function
sequential_preLN__sliding_block_cached__geglu_ffn__decode_kernel:
    s_cmp_ge_u32 s2, 256
    s_cbranch_scc1 L_END
    s_load_dwordx16 s[16:31], s[0:1], 0
    s_load_dwordx8 s[32:39], s[0:1], 64
    v_lshrrev_b32 v1, 6, v0
    v_and_b32 v0, 63, v0
    v_readfirstlane_b32 s3, v1
    s_and_b32 s4, s2, 15
    s_lshr_b32 s5, s2, 4
    s_lshr_b32 s6, s5, 2
    s_and_b32 s7, s5, 3
    v_lshrrev_b32 v8, 3, v0
    v_and_b32 v9, 7, v0
    v_lshlrev_b32 v9, 4, v9
    v_lshlrev_b32 v11, 4, v0
    v_lshl_add_u32 v10, v8, 13, v9
    s_mul_i32 s56, s6, 1179648
    s_lshl_b32 s57, s4, 9
    s_add_u32 s56, s56, s57
    s_lshl_b32 s57, s7, 7
    s_add_u32 s56, s56, s57
    s_lshl_b32 s57, s3, 17
    s_add_u32 s56, s56, s57
    s_add_u32 s57, s56, 65536
    s_lshl_b32 s58, s4, 24
    s_lshl_b32 s59, s5, 16
    s_add_u32 s58, s58, s59
    s_add_u32 s58, s58, 15728640
    s_mul_i32 s60, s6, 288
    s_lshl_b32 s61, s3, 5
    s_add_u32 s60, s60, s61
    s_add_u32 s60, s60, 160896
    v_lshl_add_u32 v59, v8, 1, s60
    s_cmp_ge_u32 s3, 8
    s_waitcnt lgkmcnt(0)
    s_mov_b32 s12, s16
    s_mov_b32 s13, s17
    s_mov_b32 s14, 1152
    s_mov_b32 s15, 0x20000
    s_cbranch_scc1 L_W89
    s_mov_b32 s8, s22
    s_mov_b32 s9, s23
    s_mov_b32 s10, 4718592
    s_mov_b32 s11, 0x20000
    buffer_load_dwordx4 v[12:15], v10, s[8:11], s56 offen nt
    buffer_load_dwordx4 v[16:19], v10, s[8:11], s57 offen nt
    s_load_dword s45, s[38:39], 0
    v_and_b32 v1, 1, v0
    v_lshlrev_b32 v1, 4, v1
    v_mov_b32 v2, 0xffff
    v_lshlrev_b32 v2, v1, v2
    v_bfe_u32 v3, v0, 1, 2
    v_cmp_eq_u32 vcc, 0, v3
    s_nop 1
    v_cndmask_b32 v4, 0, v2, vcc
    v_cmp_eq_u32 vcc, 1, v3
    s_nop 1
    v_cndmask_b32 v5, 0, v2, vcc
    v_cmp_eq_u32 vcc, 2, v3
    s_nop 1
    v_cndmask_b32 v6, 0, v2, vcc
    v_cmp_eq_u32 vcc, 3, v3
    s_nop 1
    v_cndmask_b32 v7, 0, v2, vcc
    s_and_b32 s96, s4, 7
    s_lshl_b32 s97, s5, 3
    s_add_u32 s96, s96, s97
    s_lshl_b32 s96, s96, 1
    s_lshr_b32 s97, s4, 3
    s_add_u32 s96, s96, s97
    s_mov_b32 s99, 0
    s_cmp_lt_u32 s5, 9
    s_cbranch_scc1 L_RS1
    s_sub_u32 s96, s5, 9
    s_lshl_b32 s96, s96, 3
    s_and_b32 s98, s4, 3
    s_add_u32 s96, s96, s98
    s_lshr_b32 s98, s4, 3
    s_lshl_b32 s98, s98, 2
    s_add_u32 s96, s96, s98
    s_mul_hi_u32 s97, s96, 477218589
    s_mul_i32 s98, s97, 9
    s_sub_u32 s98, s96, s98
    s_cmp_lt_u32 s96, 54
    s_cselect_b32 s99, 1, 2
    s_bitcmp1_b32 s4, 2
    s_cselect_b32 s96, 6, 0
    s_add_u32 s97, s97, s96
L_RS1:
    s_lshl_b32 s61, s3, 10
    s_add_u32 s61, s61, 139520
    v_add_u32 v63, s61, v11
    v_mov_b32 v62, 139264
    s_mov_b32 s60, 0x01000100
    s_mov_b32 s61, 0x03020302
    s_barrier
    ds_read_b64 v[64:65], v62
    ds_read_u16 v60, v59
    ds_read_u16 v61, v59 offset:16
    s_waitcnt lgkmcnt(0)
    v_lshlrev_b32 v60, 16, v60
    v_lshlrev_b32 v61, 16, v61
    v_sub_f32 v60, v60, v64
    v_sub_f32 v61, v61, v64
    v_cvt_pk_bf16_f32 v66, v60, v61
    v_lshlrev_b32 v60, 16, v66
    v_and_b32 v61, 0xffff0000, v66
    v_mul_f32 v60, v60, v65
    v_mul_f32 v61, v61, v65
    v_cvt_pk_bf16_f32 v66, v60, v61
    v_perm_b32 v60, v66, v66, s60
    v_perm_b32 v61, v66, v66, s61
    v_and_b32 v64, v60, v4
    v_and_b32 v65, v60, v5
    v_and_b32 v66, v60, v6
    v_and_b32 v67, v60, v7
    v_and_b32 v72, v61, v4
    v_and_b32 v73, v61, v5
    v_and_b32 v74, v61, v6
    v_and_b32 v75, v61, v7
    s_waitcnt vmcnt(1)
    v_mfma_f32_16x16x32_bf16 v[68:71], v[64:67], v[12:15], 0
    s_waitcnt vmcnt(0)
    v_mfma_f32_16x16x32_bf16 v[68:71], v[72:75], v[16:19], v[68:71]
    s_nop 7
    ds_write_b128 v63, v[68:71]
    s_waitcnt lgkmcnt(0)
    s_barrier
    s_add_u32 s8, s20, s58
    s_addc_u32 s9, s21, 0
    s_mov_b32 s10, 65536
    s_lshl_b32 s59, s3, 13
    s_barrier
    s_barrier
    s_barrier
    buffer_load_dwordx4 v[32:35], v11, s[8:11], s59 offen nt
    s_add_u32 s59, s59, 1024
    buffer_load_dwordx4 v[36:39], v11, s[8:11], s59 offen nt
    s_add_u32 s59, s59, 1024
    buffer_load_dwordx4 v[40:43], v11, s[8:11], s59 offen nt
    s_add_u32 s59, s59, 1024
    buffer_load_dwordx4 v[44:47], v11, s[8:11], s59 offen nt
    s_add_u32 s59, s59, 1024
    buffer_load_dwordx4 v[48:51], v11, s[8:11], s59 offen nt
    s_add_u32 s59, s59, 1024
    buffer_load_dwordx4 v[52:55], v11, s[8:11], s59 offen nt
    s_add_u32 s59, s59, 1024
    buffer_load_dwordx4 v[56:59], v11, s[8:11], s59 offen nt
    s_add_u32 s59, s59, 1024
    buffer_load_dwordx4 v[60:63], v11, s[8:11], s59 offen nt
    s_add_u32 s59, s59, 1024
    v_and_b32 v1, 15, v0
    v_lshrrev_b32 v2, 4, v0
    v_xor_b32 v3, v1, v2
    s_lshl_b32 s59, s3, 13
    v_lshl_add_u32 v64, v1, 8, s59
    v_xor_b32 v65, 0, v3
    v_lshl_add_u32 v66, v65, 4, v64
    v_xor_b32 v65, 4, v3
    v_lshl_add_u32 v67, v65, 4, v64
    v_xor_b32 v65, 8, v3
    v_lshl_add_u32 v68, v65, 4, v64
    v_xor_b32 v65, 12, v3
    v_lshl_add_u32 v69, v65, 4, v64
    v_and_b32 v65, 1, v1
    v_lshlrev_b32 v65, 8, v65
    v_lshl_add_u32 v65, v2, 4, v65
    v_add_u32 v70, 148736, v65
    v_and_b32 v65, 2, v1
    v_cmp_ne_u32 s[46:47], 0, v65
    v_and_b32 v65, 4, v1
    v_cmp_ne_u32 s[48:49], 0, v65
    v_and_b32 v65, 8, v1
    v_cmp_ne_u32 s[50:51], 0, v65
    v_and_b32 v65, 1, v1
    v_lshlrev_b32 v71, 5, v65
    v_add_u32 v71, 149248, v71
    v_bfe_u32 v72, v1, 1, 2
    v_lshl_add_u32 v72, v65, 2, v72
    v_lshlrev_b32 v72, 3, v72
    v_lshrrev_b32 v73, 3, v1
    v_lshl_add_u32 v73, v73, 2, v2
    v_add_u32 v72, v72, v73
    s_lshl_b32 s59, s3, 8
    s_add_u32 s59, s59, 149504
    v_lshl_add_u32 v72, v72, 2, s59
    v_lshrrev_b32 v73, 3, v1
    v_lshl_add_u32 v73, v73, 2, v2
    v_lshl_add_u32 v73, v73, 5, s59
    v_lshlrev_b32 v3, 5, v1
    v_and_b32 v132, 1, v2
    v_lshl_add_u32 v3, v132, 4, v3
    v_lshrrev_b32 v132, 1, v2
    v_lshl_add_u32 v132, v132, 13, v3
    s_lshl_b32 s52, s4, 14
    s_lshl_b32 s57, s5, 9
    s_add_u32 s52, s52, s57
    s_add_u32 s52, s52, 139264
    v_lshlrev_b32 v133, 8, v0
    s_lshl_b32 s53, s4, 9
    s_lshl_b32 s57, s5, 4
    s_add_u32 s53, s53, s57
    s_add_u32 s53, s53, 401408
    v_lshlrev_b32 v134, 5, v0
    v_add_u32 v134, 149248, v134
    v_add_u32 v135, 139520, v11
    s_lshl_b32 s59, s3, 10
    s_add_u32 s59, s59, 139520
    v_add_u32 v74, s59, v11
    s_mul_i32 s44, s45, 0x9E3779B1
    s_add_u32 s44, s44, 0x85EBCA6B
    s_and_b32 s44, s44, 0xBFFFBFFF
    s_mov_b32 s40, s38
    s_mov_b32 s41, s39
    s_mov_b32 s42, 2097152
    s_mov_b32 s43, 0x20000
    s_barrier
    ds_read_b128 v[76:79], v70 offset:0
    ds_read_b128 v[80:83], v70 offset:64
    ds_read_b128 v[84:87], v70 offset:128
    ds_read_b128 v[88:91], v70 offset:192
    ds_read_b128 v[92:95], v66 offset:0
    ds_read_b128 v[96:99], v67 offset:0
    ds_read_b128 v[100:103], v68 offset:0
    ds_read_b128 v[104:107], v69 offset:0
    ds_read_b128 v[108:111], v66 offset:4096
    ds_read_b128 v[112:115], v67 offset:4096
    ds_read_b128 v[116:119], v68 offset:4096
    ds_read_b128 v[120:123], v69 offset:4096
    s_waitcnt lgkmcnt(7)
    v_mfma_f32_16x16x32_bf16 v[124:127], v[92:95], v[76:79], 0
    s_waitcnt lgkmcnt(6)
    v_mfma_f32_16x16x32_bf16 v[124:127], v[96:99], v[80:83], v[124:127]
    s_waitcnt lgkmcnt(5)
    v_mfma_f32_16x16x32_bf16 v[124:127], v[100:103], v[84:87], v[124:127]
    s_waitcnt lgkmcnt(4)
    v_mfma_f32_16x16x32_bf16 v[124:127], v[104:107], v[88:91], v[124:127]
    s_waitcnt lgkmcnt(3)
    v_mfma_f32_16x16x32_bf16 v[128:131], v[108:111], v[76:79], 0
    s_waitcnt lgkmcnt(2)
    v_mfma_f32_16x16x32_bf16 v[128:131], v[112:115], v[80:83], v[128:131]
    s_waitcnt lgkmcnt(1)
    v_mfma_f32_16x16x32_bf16 v[128:131], v[116:119], v[84:87], v[128:131]
    s_waitcnt lgkmcnt(0)
    v_mfma_f32_16x16x32_bf16 v[128:131], v[120:123], v[88:91], v[128:131]
    v_cndmask_b32 v92, v124, v125, s[46:47]
    v_cndmask_b32 v93, v126, v127, s[46:47]
    s_nop 5
    v_cndmask_b32 v94, v128, v129, s[46:47]
    v_cndmask_b32 v95, v130, v131, s[46:47]
    v_cndmask_b32 v92, v92, v93, s[48:49]
    v_cndmask_b32 v94, v94, v95, s[48:49]
    v_cndmask_b32 v92, v92, v94, s[50:51]
    v_cvt_pk_bf16_f32 v92, v92, v92
    v_lshlrev_b32 v92, 16, v92
    v_mul_f32 v92, 0x3db504f3, v92
    v_cvt_pk_bf16_f32 v92, v92, v92
    v_lshlrev_b32 v92, 16, v92
    v_mov_b32 v93, v92
    s_nop 1
    v_max_f32_dpp v93, v93, v93 quad_perm:[2,3,0,1] row_mask:0xf bank_mask:0xf
    s_nop 1
    v_max_f32_dpp v93, v93, v93 row_ror:4 row_mask:0xf bank_mask:0xf
    s_nop 1
    v_max_f32_dpp v93, v93, v93 row_ror:8 row_mask:0xf bank_mask:0xf
    v_mov_b32 v94, v93
    s_nop 1
    v_permlane16_swap_b32 v94, v93
    v_max_f32 v93, v93, v94
    v_mov_b32 v94, v93
    s_nop 1
    v_permlane32_swap_b32 v94, v93
    v_max_f32 v93, v93, v94
    s_lshl_b32 s59, s3, 2
    v_add_u32 v95, s59, v71
    ds_write_b32 v95, v93
    v_mov_b32 v1, 139280
    v_mov_b32 v2, 1
    s_waitcnt lgkmcnt(0)
    s_mov_b64 exec, 1
    ds_add_u32 v1, v2
    s_mov_b64 exec, -1
    v_mov_b32 v1, 139280
    s_mov_b32 s63, 200000
L_LW1:
    ds_read_b32 v2, v1
    s_waitcnt lgkmcnt(0)
    v_readfirstlane_b32 s61, v2
    s_nop 0
    s_cmp_ge_u32 s61, 8
    s_cbranch_scc1 L_LW1_out
    s_sub_u32 s63, s63, 1
    s_cbranch_scc0 L_LW1
L_LW1_out:
    ds_read_b128 v[96:99], v71
    ds_read_b128 v[100:103], v71 offset:16
    s_waitcnt lgkmcnt(0)
    v_max3_f32 v96, v96, v97, v98
    v_max3_f32 v99, v99, v100, v101
    v_max3_f32 v96, v96, v102, v103
    v_max_f32 v96, v96, v99
    v_sub_f32 v92, v92, v96
    v_mul_f32 v92, 0x3fb8aa3b, v92
    v_exp_f32 v92, v92
    s_nop 0
    v_cvt_pk_bf16_f32 v93, v92, v92
    ds_write_b32 v72, v93
    v_add_f32_dpp v92, v92, v92 quad_perm:[2,3,0,1] row_mask:0xf bank_mask:0xf
    s_nop 1
    v_add_f32_dpp v92, v92, v92 row_ror:4 row_mask:0xf bank_mask:0xf
    s_nop 1
    v_add_f32_dpp v92, v92, v92 row_ror:8 row_mask:0xf bank_mask:0xf
    v_mov_b32 v94, v92
    s_nop 1
    v_permlane16_swap_b32 v94, v92
    v_add_f32 v92, v92, v94
    v_mov_b32 v94, v92
    s_nop 1
    v_permlane32_swap_b32 v94, v92
    v_add_f32 v92, v92, v94
    ds_write_b32 v95, v92 offset:128
    s_waitcnt lgkmcnt(0)
    ds_read_b128 v[96:99], v73
    ds_read_b128 v[100:103], v73 offset:16
    s_waitcnt lgkmcnt(0)
    v_mov_b32 v130, 139284
    v_mov_b32 v131, 1
    v_and_b32 v104, v96, v4
    v_and_b32 v105, v96, v5
    v_and_b32 v106, v96, v6
    v_and_b32 v107, v96, v7
    v_and_b32 v108, v97, v4
    v_and_b32 v109, v97, v5
    v_and_b32 v110, v97, v6
    v_and_b32 v111, v97, v7
    s_waitcnt vmcnt(7)
    v_mfma_f32_16x16x32_bf16 v[112:115], v[104:107], v[32:35], 0
    v_and_b32 v104, v98, v4
    v_and_b32 v105, v98, v5
    v_and_b32 v106, v98, v6
    v_and_b32 v107, v98, v7
    s_waitcnt vmcnt(6)
    v_mfma_f32_16x16x32_bf16 v[112:115], v[108:111], v[36:39], v[112:115]
    v_and_b32 v108, v99, v4
    v_and_b32 v109, v99, v5
    v_and_b32 v110, v99, v6
    v_and_b32 v111, v99, v7
    s_waitcnt vmcnt(5)
    v_mfma_f32_16x16x32_bf16 v[112:115], v[104:107], v[40:43], v[112:115]
    v_and_b32 v104, v100, v4
    v_and_b32 v105, v100, v5
    v_and_b32 v106, v100, v6
    v_and_b32 v107, v100, v7
    s_waitcnt vmcnt(4)
    v_mfma_f32_16x16x32_bf16 v[112:115], v[108:111], v[44:47], v[112:115]
    v_and_b32 v108, v101, v4
    v_and_b32 v109, v101, v5
    v_and_b32 v110, v101, v6
    v_and_b32 v111, v101, v7
    s_waitcnt vmcnt(3)
    v_mfma_f32_16x16x32_bf16 v[112:115], v[104:107], v[48:51], v[112:115]
    v_and_b32 v104, v102, v4
    v_and_b32 v105, v102, v5
    v_and_b32 v106, v102, v6
    v_and_b32 v107, v102, v7
    s_waitcnt vmcnt(2)
    v_mfma_f32_16x16x32_bf16 v[112:115], v[108:111], v[52:55], v[112:115]
    v_and_b32 v108, v103, v4
    v_and_b32 v109, v103, v5
    v_and_b32 v110, v103, v6
    v_and_b32 v111, v103, v7
    s_waitcnt vmcnt(1)
    v_mfma_f32_16x16x32_bf16 v[112:115], v[104:107], v[56:59], v[112:115]
    s_waitcnt vmcnt(0)
    v_mfma_f32_16x16x32_bf16 v[112:115], v[108:111], v[60:63], v[112:115]
    s_nop 7
    ds_write_b128 v74, v[112:115]
    s_mov_b64 exec, 1
    ds_add_rtn_u32 v131, v130, v131
    s_mov_b64 exec, -1
    s_waitcnt lgkmcnt(0)
    v_readfirstlane_b32 s61, v131
    s_nop 0
    s_cmp_eq_u32 s61, 7
    s_cbranch_scc0 L_ROLE
    ds_read_b128 v[80:83], v135 offset:0
    ds_read_b128 v[84:87], v135 offset:1024
    ds_read_b128 v[88:91], v135 offset:2048
    ds_read_b128 v[92:95], v135 offset:3072
    ds_read_b128 v[96:99], v135 offset:4096
    ds_read_b128 v[100:103], v135 offset:5120
    ds_read_b128 v[104:107], v135 offset:6144
    ds_read_b128 v[108:111], v135 offset:7168
    s_mov_b64 exec, 3
    ds_read_b128 v[112:115], v134
    ds_read_b128 v[116:119], v134 offset:16
    ds_read_b128 v[120:123], v134 offset:128
    ds_read_b128 v[124:127], v134 offset:144
    s_mov_b64 exec, -1
    s_waitcnt lgkmcnt(4)
    v_pk_add_f32 v[80:81], v[80:81], v[84:85]
    v_pk_add_f32 v[82:83], v[82:83], v[86:87]
    v_pk_add_f32 v[80:81], v[80:81], v[88:89]
    v_pk_add_f32 v[82:83], v[82:83], v[90:91]
    v_pk_add_f32 v[80:81], v[80:81], v[92:93]
    v_pk_add_f32 v[82:83], v[82:83], v[94:95]
    v_pk_add_f32 v[80:81], v[80:81], v[96:97]
    v_pk_add_f32 v[82:83], v[82:83], v[98:99]
    v_pk_add_f32 v[80:81], v[80:81], v[100:101]
    v_pk_add_f32 v[82:83], v[82:83], v[102:103]
    v_pk_add_f32 v[80:81], v[80:81], v[104:105]
    v_pk_add_f32 v[82:83], v[82:83], v[106:107]
    v_pk_add_f32 v[80:81], v[80:81], v[108:109]
    v_pk_add_f32 v[82:83], v[82:83], v[110:111]
    v_cvt_pk_bf16_f32 v84, v80, v81
    v_cvt_pk_bf16_f32 v86, v82, v83
    v_mov_b32 v85, s44
    v_mov_b32 v87, s44
    buffer_store_dwordx4 v[84:87], v132, s[40:43], s52 offen sc1
    s_waitcnt lgkmcnt(0)
    v_max3_f32 v112, v112, v113, v114
    v_max3_f32 v115, v115, v116, v117
    v_max3_f32 v112, v112, v118, v119
    v_max_f32 v112, v112, v115
    v_pk_add_f32 v[120:121], v[120:121], v[122:123]
    v_pk_add_f32 v[124:125], v[124:125], v[126:127]
    v_pk_add_f32 v[120:121], v[120:121], v[124:125]
    v_add_f32 v114, v120, v121
    v_mov_b32 v113, s44
    v_mov_b32 v115, s44
    s_mov_b64 exec, 3
    buffer_store_dwordx4 v[112:115], v133, s[40:43], s53 offen sc1
    s_mov_b64 exec, -1
    v_mov_b32 v1, 139304
    v_mov_b32 v2, 1
    ds_write_b32 v1, v2
    s_branch L_ROLE
L_W89:
    s_cmp_eq_u32 s3, 9
    s_cbranch_scc1 L_W9
    s_setprio 3
    v_lshlrev_b32 v1, 1, v0
    buffer_load_dwordx4 v[20:23], v11, s[12:15], 0 offen
    buffer_load_ushort v24, v1, s[12:15], 0 offen offset:1024
    s_mov_b32 s8, s22
    s_mov_b32 s9, s23
    s_mov_b32 s10, 4718592
    s_mov_b32 s11, 0x20000
    buffer_load_dwordx4 v[12:15], v10, s[8:11], s56 offen nt
    buffer_load_dwordx4 v[16:19], v10, s[8:11], s57 offen nt
    s_load_dword s45, s[38:39], 0
    v_and_b32 v1, 1, v0
    v_lshlrev_b32 v1, 4, v1
    v_mov_b32 v2, 0xffff
    v_lshlrev_b32 v2, v1, v2
    v_bfe_u32 v3, v0, 1, 2
    v_cmp_eq_u32 vcc, 0, v3
    s_nop 1
    v_cndmask_b32 v4, 0, v2, vcc
    v_cmp_eq_u32 vcc, 1, v3
    s_nop 1
    v_cndmask_b32 v5, 0, v2, vcc
    v_cmp_eq_u32 vcc, 2, v3
    s_nop 1
    v_cndmask_b32 v6, 0, v2, vcc
    v_cmp_eq_u32 vcc, 3, v3
    s_nop 1
    v_cndmask_b32 v7, 0, v2, vcc
    s_and_b32 s96, s4, 7
    s_lshl_b32 s97, s5, 3
    s_add_u32 s96, s96, s97
    s_lshl_b32 s96, s96, 1
    s_lshr_b32 s97, s4, 3
    s_add_u32 s96, s96, s97
    s_mov_b32 s99, 0
    s_cmp_lt_u32 s5, 9
    s_cbranch_scc1 L_RS2
    s_sub_u32 s96, s5, 9
    s_lshl_b32 s96, s96, 3
    s_and_b32 s98, s4, 3
    s_add_u32 s96, s96, s98
    s_lshr_b32 s98, s4, 3
    s_lshl_b32 s98, s98, 2
    s_add_u32 s96, s96, s98
    s_mul_hi_u32 s97, s96, 477218589
    s_mul_i32 s98, s97, 9
    s_sub_u32 s98, s96, s98
    s_cmp_lt_u32 s96, 54
    s_cselect_b32 s99, 1, 2
    s_bitcmp1_b32 s4, 2
    s_cselect_b32 s96, 6, 0
    s_add_u32 s97, s97, s96
L_RS2:
    v_and_b32 v1, 7, v0
    v_lshlrev_b32 v58, 6, v1
    v_bfe_u32 v3, v0, 4, 1
    v_lshl_add_u32 v58, v3, 5, v58
    v_lshrrev_b32 v3, 5, v0
    v_lshl_add_u32 v58, v3, 4, v58
    s_lshl_b32 s55, s4, 13
    s_lshl_b32 s57, s6, 11
    s_add_u32 s55, s55, s57
    s_lshl_b32 s57, s7, 9
    s_add_u32 s55, s55, s57
    s_add_u32 s55, s55, 4096
    s_waitcnt lgkmcnt(0)
    s_mov_b32 s40, s38
    s_mov_b32 s41, s39
    s_mov_b32 s42, 2097152
    s_mov_b32 s43, 0x20000
    s_mul_i32 s44, s45, 0x9E3779B1
    s_add_u32 s44, s44, 0x85EBCA6B
    s_and_b32 s44, s44, 0xBFFFBFFF
    v_mov_b32 v29, s44
    v_mov_b32 v31, s44
    v_add_u32 v25, 160896, v11
    v_lshlrev_b32 v26, 1, v0
    v_add_u32 v26, 161920, v26
    s_waitcnt vmcnt(2)
    ds_write_b128 v25, v[20:23]
    ds_write_b16 v26, v24
    v_lshlrev_b32 v32, 16, v20
    v_and_b32 v33, 0xffff0000, v20
    v_lshlrev_b32 v34, 16, v21
    v_and_b32 v35, 0xffff0000, v21
    v_lshlrev_b32 v36, 16, v22
    v_and_b32 v37, 0xffff0000, v22
    v_lshlrev_b32 v38, 16, v23
    v_and_b32 v39, 0xffff0000, v23
    v_lshlrev_b32 v40, 16, v24
    v_readfirstlane_b32 s60, v32
    s_nop 1
    v_subrev_f32 v32, s60, v32
    v_subrev_f32 v33, s60, v33
    v_subrev_f32 v34, s60, v34
    v_subrev_f32 v35, s60, v35
    v_subrev_f32 v36, s60, v36
    v_subrev_f32 v37, s60, v37
    v_subrev_f32 v38, s60, v38
    v_subrev_f32 v39, s60, v39
    v_subrev_f32 v40, s60, v40
    v_pk_add_f32 v[42:43], v[32:33], v[34:35]
    v_pk_mul_f32 v[44:45], v[32:33], v[32:33]
    v_pk_add_f32 v[42:43], v[42:43], v[36:37]
    v_pk_fma_f32 v[44:45], v[34:35], v[34:35], v[44:45]
    v_pk_add_f32 v[42:43], v[42:43], v[38:39]
    v_pk_fma_f32 v[44:45], v[36:37], v[36:37], v[44:45]
    v_add_f32 v42, v42, v40
    v_pk_fma_f32 v[44:45], v[38:39], v[38:39], v[44:45]
    v_add_f32 v42, v42, v43
    v_fmac_f32 v44, v40, v40
    v_add_f32 v44, v44, v45
    v_add_f32_dpp v42, v42, v42 quad_perm:[1,0,3,2] row_mask:0xf bank_mask:0xf
    s_nop 0
    v_add_f32_dpp v44, v44, v44 quad_perm:[1,0,3,2] row_mask:0xf bank_mask:0xf
    v_add_f32_dpp v42, v42, v42 quad_perm:[2,3,0,1] row_mask:0xf bank_mask:0xf
    s_nop 0
    v_add_f32_dpp v44, v44, v44 quad_perm:[2,3,0,1] row_mask:0xf bank_mask:0xf
    v_add_f32_dpp v42, v42, v42 row_ror:4 row_mask:0xf bank_mask:0xf
    s_nop 0
    v_add_f32_dpp v44, v44, v44 row_ror:4 row_mask:0xf bank_mask:0xf
    v_add_f32_dpp v42, v42, v42 row_ror:8 row_mask:0xf bank_mask:0xf
    s_nop 0
    v_add_f32_dpp v44, v44, v44 row_ror:8 row_mask:0xf bank_mask:0xf
    v_mov_b32 v46, v42
    v_mov_b32 v47, v44
    s_nop 0
    v_permlane16_swap_b32 v46, v42
    v_permlane16_swap_b32 v47, v44
    v_add_f32 v42, v42, v46
    v_add_f32 v44, v44, v47
    v_mov_b32 v46, v42
    v_mov_b32 v47, v44
    s_nop 0
    v_permlane32_swap_b32 v46, v42
    v_permlane32_swap_b32 v47, v44
    v_add_f32 v42, v42, v46
    v_add_f32 v44, v44, v47
    v_mul_f32 v42, 0x3ae38e39, v42
    v_mul_f32 v44, 0x3ae38e39, v44
    v_fma_f32 v44, -v42, v42, v44
    v_max_f32 v44, 0, v44
    v_add_f32 v42, s60, v42
    v_cvt_pk_bf16_f32 v52, v42, v42
    v_lshlrev_b32 v52, 16, v52
    v_cvt_pk_bf16_f32 v49, v44, v44
    v_lshlrev_b32 v49, 16, v49
    v_add_f32 v49, 0x3727c5ac, v49
    v_cvt_pk_bf16_f32 v49, v49, v49
    v_lshlrev_b32 v49, 16, v49
    v_sqrt_f32 v49, v49
    s_nop 0
    v_cvt_pk_bf16_f32 v49, v49, v49
    v_lshlrev_b32 v49, 16, v49
    v_rcp_f32 v53, v49
    v_mov_b32 v54, 139264
    ds_write_b64 v54, v[52:53]
    s_waitcnt lgkmcnt(0)
    s_lshl_b32 s61, s3, 10
    s_add_u32 s61, s61, 139520
    v_add_u32 v63, s61, v11
    v_mov_b32 v62, 139264
    s_mov_b32 s60, 0x01000100
    s_mov_b32 s61, 0x03020302
    s_barrier
    ds_read_b64 v[64:65], v62
    ds_read_u16 v60, v59
    ds_read_u16 v61, v59 offset:16
    s_waitcnt lgkmcnt(0)
    v_lshlrev_b32 v60, 16, v60
    v_lshlrev_b32 v61, 16, v61
    v_sub_f32 v60, v60, v64
    v_sub_f32 v61, v61, v64
    v_cvt_pk_bf16_f32 v66, v60, v61
    v_lshlrev_b32 v60, 16, v66
    v_and_b32 v61, 0xffff0000, v66
    v_mul_f32 v60, v60, v65
    v_mul_f32 v61, v61, v65
    v_cvt_pk_bf16_f32 v66, v60, v61
    v_perm_b32 v60, v66, v66, s60
    v_perm_b32 v61, v66, v66, s61
    v_and_b32 v64, v60, v4
    v_and_b32 v65, v60, v5
    v_and_b32 v66, v60, v6
    v_and_b32 v67, v60, v7
    v_and_b32 v72, v61, v4
    v_and_b32 v73, v61, v5
    v_and_b32 v74, v61, v6
    v_and_b32 v75, v61, v7
    s_waitcnt vmcnt(1)
    v_mfma_f32_16x16x32_bf16 v[68:71], v[64:67], v[12:15], 0
    s_waitcnt vmcnt(0)
    v_mfma_f32_16x16x32_bf16 v[68:71], v[72:75], v[16:19], v[68:71]
    s_nop 7
    ds_write_b128 v63, v[68:71]
    s_waitcnt lgkmcnt(0)
    s_barrier
    v_add_u32 v63, 139520, v11
    ds_read_b128 v[80:83], v63 offset:0
    ds_read_b128 v[84:87], v63 offset:1024
    ds_read_b128 v[88:91], v63 offset:2048
    ds_read_b128 v[92:95], v63 offset:3072
    ds_read_b128 v[96:99], v63 offset:4096
    ds_read_b128 v[100:103], v63 offset:5120
    ds_read_b128 v[104:107], v63 offset:6144
    ds_read_b128 v[108:111], v63 offset:7168
    ds_read_b128 v[112:115], v63 offset:8192
    s_waitcnt lgkmcnt(0)
    v_pk_add_f32 v[80:81], v[80:81], v[84:85]
    v_pk_add_f32 v[82:83], v[82:83], v[86:87]
    v_pk_add_f32 v[80:81], v[80:81], v[88:89]
    v_pk_add_f32 v[82:83], v[82:83], v[90:91]
    v_pk_add_f32 v[80:81], v[80:81], v[92:93]
    v_pk_add_f32 v[82:83], v[82:83], v[94:95]
    v_pk_add_f32 v[80:81], v[80:81], v[96:97]
    v_pk_add_f32 v[82:83], v[82:83], v[98:99]
    v_pk_add_f32 v[80:81], v[80:81], v[100:101]
    v_pk_add_f32 v[82:83], v[82:83], v[102:103]
    v_pk_add_f32 v[80:81], v[80:81], v[104:105]
    v_pk_add_f32 v[82:83], v[82:83], v[106:107]
    v_pk_add_f32 v[80:81], v[80:81], v[108:109]
    v_pk_add_f32 v[82:83], v[82:83], v[110:111]
    v_pk_add_f32 v[80:81], v[80:81], v[112:113]
    v_pk_add_f32 v[82:83], v[82:83], v[114:115]
    s_nop 1
    v_permlane32_swap_b32 v80, v82
    v_permlane32_swap_b32 v81, v83
    s_nop 0
    v_add_f32_dpp v80, v82, v80 row_ror:8 row_mask:0xf bank_mask:0xf
    v_add_f32_dpp v81, v83, v81 row_ror:8 row_mask:0xf bank_mask:0xf
    v_mov_b32 v28, v80
    v_mov_b32 v30, v81
    s_mov_b32 exec_lo, 0x00ff00ff
    s_mov_b32 exec_hi, 0x00ff00ff
    buffer_store_dwordx4 v[28:31], v58, s[40:43], s55 offen sc1
    s_lshl_b32 s57, s4, 7
    s_mov_b64 exec, -1
    s_barrier
    s_add_u32 s57, s57, 851968
    s_add_u32 s12, s38, s57
    s_addc_u32 s13, s39, 0
    s_lshl_b32 s56, s4, 13
    s_add_u32 s56, s56, 4096
    s_mov_b32 s62, 200000
    s_barrier
    s_add_u32 s57, s56, 0
    buffer_load_dwordx4 v[80:83], v11, s[40:43], s57 offen sc1
    s_add_u32 s57, s56, 1024
    buffer_load_dwordx4 v[84:87], v11, s[40:43], s57 offen sc1
    s_add_u32 s57, s56, 2048
    buffer_load_dwordx4 v[88:91], v11, s[40:43], s57 offen sc1
    s_add_u32 s57, s56, 3072
    buffer_load_dwordx4 v[92:95], v11, s[40:43], s57 offen sc1
    s_add_u32 s57, s56, 4096
    buffer_load_dwordx4 v[96:99], v11, s[40:43], s57 offen sc1
    s_add_u32 s57, s56, 5120
    buffer_load_dwordx4 v[100:103], v11, s[40:43], s57 offen sc1
    s_add_u32 s57, s56, 6144
    buffer_load_dwordx4 v[104:107], v11, s[40:43], s57 offen sc1
    s_add_u32 s57, s56, 7168
    buffer_load_dwordx4 v[108:111], v11, s[40:43], s57 offen sc1
    s_barrier
    s_branch L_QG_W
L_QG:
    s_add_u32 s57, s56, 0
    buffer_load_dwordx4 v[80:83], v11, s[40:43], s57 offen sc1
    s_add_u32 s57, s56, 1024
    buffer_load_dwordx4 v[84:87], v11, s[40:43], s57 offen sc1
    s_add_u32 s57, s56, 2048
    buffer_load_dwordx4 v[88:91], v11, s[40:43], s57 offen sc1
    s_add_u32 s57, s56, 3072
    buffer_load_dwordx4 v[92:95], v11, s[40:43], s57 offen sc1
    s_add_u32 s57, s56, 4096
    buffer_load_dwordx4 v[96:99], v11, s[40:43], s57 offen sc1
    s_add_u32 s57, s56, 5120
    buffer_load_dwordx4 v[100:103], v11, s[40:43], s57 offen sc1
    s_add_u32 s57, s56, 6144
    buffer_load_dwordx4 v[104:107], v11, s[40:43], s57 offen sc1
    s_add_u32 s57, s56, 7168
    buffer_load_dwordx4 v[108:111], v11, s[40:43], s57 offen sc1
L_QG_W:
    s_waitcnt vmcnt(0)
    v_bitop3_b32 v112, v81, v83, s44 bitop3:0x7e
    v_bitop3_b32 v113, v85, v87, s44 bitop3:0x7e
    v_bitop3_b32 v114, v89, v91, s44 bitop3:0x7e
    v_bitop3_b32 v115, v93, v95, s44 bitop3:0x7e
    v_bitop3_b32 v116, v97, v99, s44 bitop3:0x7e
    v_bitop3_b32 v117, v101, v103, s44 bitop3:0x7e
    v_bitop3_b32 v118, v105, v107, s44 bitop3:0x7e
    v_bitop3_b32 v119, v109, v111, s44 bitop3:0x7e
    v_or3_b32 v112, v112, v113, v114
    v_or3_b32 v115, v115, v116, v117
    v_or3_b32 v112, v112, v118, v119
    v_or_b32 v112, v112, v115
    v_cmp_ne_u32 vcc, 0, v112
    s_sub_u32 s62, s62, 1
    s_cbranch_scc1 L_QG_out
    s_cbranch_vccnz L_QG
L_QG_out:
    v_add_f32 v80, v80, v88
    v_add_f32 v82, v82, v90
    v_add_f32 v80, v80, v96
    v_add_f32 v82, v82, v98
    v_add_f32 v80, v80, v104
    v_add_f32 v82, v82, v106
    v_cvt_pk_bf16_f32 v80, v80, v82
    v_add_f32 v84, v84, v92
    v_add_f32 v86, v86, v94
    v_add_f32 v84, v84, v100
    v_add_f32 v86, v86, v102
    v_add_f32 v84, v84, v108
    v_add_f32 v86, v86, v110
    v_cvt_pk_bf16_f32 v84, v84, v86
    v_lshlrev_b32 v1, 2, v0
    v_add_u32 v1, 148736, v1
    ds_write_b32 v1, v80
    ds_write_b32 v1, v84 offset:256
    s_waitcnt lgkmcnt(0)
    s_setprio 0
    s_barrier
    s_branch L_ROLE
L_W9:
    v_lshrrev_b32 v1, 4, v0
    v_and_b32 v2, 15, v0
    v_xor_b32 v2, v2, v1
    v_lshlrev_b32 v1, 8, v1
    v_lshl_add_u32 v28, v2, 4, v1
    v_xor_b32 v3, 4, v2
    v_lshl_add_u32 v29, v3, 4, v1
    v_xor_b32 v3, 8, v2
    v_lshl_add_u32 v30, v3, 4, v1
    v_xor_b32 v3, 12, v2
    v_lshl_add_u32 v31, v3, 4, v1
    v_lshlrev_b32 v1, 2, v0
    v_add_u32 v1, 139280, v1
    v_mov_b32 v2, 0
    s_mov_b64 exec, 0xfff
    ds_write_b32 v1, v2
    s_mov_b64 exec, -1
    s_mov_b32 s14, 65536
    s_mov_b32 s15, 0x20000
    s_waitcnt lgkmcnt(0)
    s_add_u32 s12, s18, s58
    s_addc_u32 s13, s19, 0
    s_mul_i32 s59, s5, 1
    s_mul_i32 s60, s4, 0
    s_add_u32 s59, s59, s60
    s_lshl_b32 s59, s59, 12
    s_and_b32 s59, s59, 0xffff
    s_mov_b32 m0, s59
    s_nop 0
    buffer_load_dwordx4 v28, s[12:15], s59 offen nt lds
    s_add_u32 m0, m0, 1024
    s_add_u32 s59, s59, 1024
    buffer_load_dwordx4 v29, s[12:15], s59 offen nt lds
    s_add_u32 m0, m0, 1024
    s_add_u32 s59, s59, 1024
    buffer_load_dwordx4 v30, s[12:15], s59 offen nt lds
    s_add_u32 m0, m0, 1024
    s_add_u32 s59, s59, 1024
    buffer_load_dwordx4 v31, s[12:15], s59 offen nt lds
    s_add_u32 m0, m0, 1024
    s_add_u32 s59, s59, 1024
    s_and_b32 s59, s59, 0xffff
    s_mov_b32 m0, s59
    s_nop 0
    buffer_load_dwordx4 v28, s[12:15], s59 offen nt lds
    s_add_u32 m0, m0, 1024
    s_add_u32 s59, s59, 1024
    buffer_load_dwordx4 v29, s[12:15], s59 offen nt lds
    s_add_u32 m0, m0, 1024
    s_add_u32 s59, s59, 1024
    buffer_load_dwordx4 v30, s[12:15], s59 offen nt lds
    s_add_u32 m0, m0, 1024
    s_add_u32 s59, s59, 1024
    buffer_load_dwordx4 v31, s[12:15], s59 offen nt lds
    s_add_u32 m0, m0, 1024
    s_add_u32 s59, s59, 1024
    s_and_b32 s59, s59, 0xffff
    s_mov_b32 m0, s59
    s_nop 0
    buffer_load_dwordx4 v28, s[12:15], s59 offen nt lds
    s_add_u32 m0, m0, 1024
    s_add_u32 s59, s59, 1024
    buffer_load_dwordx4 v29, s[12:15], s59 offen nt lds
    s_add_u32 m0, m0, 1024
    s_add_u32 s59, s59, 1024
    buffer_load_dwordx4 v30, s[12:15], s59 offen nt lds
    s_add_u32 m0, m0, 1024
    s_add_u32 s59, s59, 1024
    buffer_load_dwordx4 v31, s[12:15], s59 offen nt lds
    s_add_u32 m0, m0, 1024
    s_add_u32 s59, s59, 1024
    s_and_b32 s59, s59, 0xffff
    s_mov_b32 m0, s59
    s_and_b32 s96, s4, 7
    s_lshl_b32 s97, s5, 3
    s_add_u32 s96, s96, s97
    s_lshl_b32 s96, s96, 1
    s_lshr_b32 s97, s4, 3
    s_add_u32 s96, s96, s97
    s_mov_b32 s99, 0
    s_cmp_lt_u32 s5, 9
    s_cbranch_scc1 L_RS3
    s_sub_u32 s96, s5, 9
    s_lshl_b32 s96, s96, 3
    s_and_b32 s98, s4, 3
    s_add_u32 s96, s96, s98
    s_lshr_b32 s98, s4, 3
    s_lshl_b32 s98, s98, 2
    s_add_u32 s96, s96, s98
    s_mul_hi_u32 s97, s96, 477218589
    s_mul_i32 s98, s97, 9
    s_sub_u32 s98, s96, s98
    s_cmp_lt_u32 s96, 54
    s_cselect_b32 s99, 1, 2
    s_bitcmp1_b32 s4, 2
    s_cselect_b32 s96, 6, 0
    s_add_u32 s97, s97, s96
L_RS3:
    s_waitcnt lgkmcnt(0)
    s_barrier
    buffer_load_dwordx4 v28, s[12:15], s59 offen nt lds
    s_add_u32 m0, m0, 1024
    s_add_u32 s59, s59, 1024
    buffer_load_dwordx4 v29, s[12:15], s59 offen nt lds
    s_add_u32 m0, m0, 1024
    s_add_u32 s59, s59, 1024
    buffer_load_dwordx4 v30, s[12:15], s59 offen nt lds
    s_add_u32 m0, m0, 1024
    s_add_u32 s59, s59, 1024
    buffer_load_dwordx4 v31, s[12:15], s59 offen nt lds
    s_add_u32 m0, m0, 1024
    s_add_u32 s59, s59, 1024
    s_and_b32 s59, s59, 0xffff
    s_mov_b32 m0, s59
    s_nop 0
    buffer_load_dwordx4 v28, s[12:15], s59 offen nt lds
    s_add_u32 m0, m0, 1024
    s_add_u32 s59, s59, 1024
    buffer_load_dwordx4 v29, s[12:15], s59 offen nt lds
    s_add_u32 m0, m0, 1024
    s_add_u32 s59, s59, 1024
    buffer_load_dwordx4 v30, s[12:15], s59 offen nt lds
    s_add_u32 m0, m0, 1024
    s_add_u32 s59, s59, 1024
    buffer_load_dwordx4 v31, s[12:15], s59 offen nt lds
    s_add_u32 m0, m0, 1024
    s_add_u32 s59, s59, 1024
    s_and_b32 s59, s59, 0xffff
    s_mov_b32 m0, s59
    s_barrier
    s_barrier
    s_mov_b32 s58, 11
L_W9_K:
    buffer_load_dwordx4 v28, s[12:15], s59 offen nt lds
    s_add_u32 m0, m0, 1024
    s_add_u32 s59, s59, 1024
    buffer_load_dwordx4 v29, s[12:15], s59 offen nt lds
    s_add_u32 m0, m0, 1024
    s_add_u32 s59, s59, 1024
    buffer_load_dwordx4 v30, s[12:15], s59 offen nt lds
    s_add_u32 m0, m0, 1024
    s_add_u32 s59, s59, 1024
    buffer_load_dwordx4 v31, s[12:15], s59 offen nt lds
    s_add_u32 m0, m0, 1024
    s_add_u32 s59, s59, 1024
    s_and_b32 s59, s59, 0xffff
    s_mov_b32 m0, s59
    s_sub_u32 s58, s58, 1
    s_cmp_lg_u32 s58, 0
    s_cbranch_scc1 L_W9_K
    s_barrier
    s_barrier
    s_cmp_eq_u32 s99, 0
    s_cbranch_scc0 L_W9_X
    s_mov_b32 s8, s28
    s_mov_b32 s9, s29
    s_mov_b32 s10, 5308416
    s_mov_b32 s11, 0x20000
    s_mov_b32 s12, s30
    s_mov_b32 s13, s31
    s_mov_b32 s14, 5308416
    s_mov_b32 s15, 0x20000
    v_lshrrev_b32 v1, 2, v0
    v_mul_u32_u24 v1, 9216, v1
    v_and_b32 v2, 3, v0
    v_lshl_add_u32 v12, v2, 4, v1
    v_mul_u32_u24 v10, 1152, v8
    v_add_u32 v10, v10, v9
    s_waitcnt vmcnt(0)
    s_barrier
    s_xor_b32 s58, s97, 0
    s_mul_i32 s56, s58, 2654208
    s_lshl_b32 s57, s96, 6
    s_add_u32 s56, s56, s57
    s_mul_i32 s57, s58, 18432
    s_add_u32 s57, s57, 65536
    s_mov_b32 s58, 6
L_W9_GUE:
    s_mov_b32 m0, s57
    s_add_u32 s57, s57, 1024
    buffer_load_dwordx4 v12, s[8:11], s56 offen  lds
    s_add_u32 m0, m0, 36864
    s_sub_u32 s58, s58, 1
    buffer_load_dwordx4 v12, s[12:15], s56 offen  lds
    s_add_u32 s56, s56, 147456
    s_cmp_lg_u32 s58, 0
    s_cbranch_scc1 L_W9_GUE
    v_mov_b32 v1, 139304
    s_mov_b32 s63, 200000
L_LW2:
    ds_read_b32 v2, v1
    s_waitcnt lgkmcnt(0)
    v_readfirstlane_b32 s61, v2
    s_nop 0
    s_cmp_ge_u32 s61, 1
    s_cbranch_scc1 L_LW2_out
    s_sub_u32 s63, s63, 1
    s_cbranch_scc0 L_LW2
L_LW2_out:
    s_mov_b32 s58, 12
L_W9_GU0:
    s_mov_b32 m0, s57
    s_add_u32 s57, s57, 1024
    buffer_load_dwordx4 v12, s[8:11], s56 offen  lds
    s_add_u32 m0, m0, 36864
    s_sub_u32 s58, s58, 1
    buffer_load_dwordx4 v12, s[12:15], s56 offen  lds
    s_add_u32 s56, s56, 147456
    s_cmp_lg_u32 s58, 0
    s_cbranch_scc1 L_W9_GU0
    s_xor_b32 s58, s97, 1
    s_mul_i32 s56, s58, 2654208
    s_lshl_b32 s57, s96, 6
    s_add_u32 s56, s56, s57
    s_mul_i32 s57, s58, 18432
    s_add_u32 s57, s57, 65536
    s_mov_b32 s58, 18
L_W9_GU1:
    s_mov_b32 m0, s57
    s_add_u32 s57, s57, 1024
    buffer_load_dwordx4 v12, s[8:11], s56 offen  lds
    s_add_u32 m0, m0, 36864
    s_sub_u32 s58, s58, 1
    buffer_load_dwordx4 v12, s[12:15], s56 offen  lds
    s_add_u32 s56, s56, 147456
    s_cmp_lg_u32 s58, 0
    s_cbranch_scc1 L_W9_GU1
    v_mov_b32 v1, 139280
    s_mov_b32 s63, 200000
L_LW3:
    ds_read_b32 v2, v1
    s_waitcnt lgkmcnt(0)
    v_readfirstlane_b32 s61, v2
    s_nop 0
    s_cmp_ge_u32 s61, 8
    s_cbranch_scc1 L_LW3_out
    s_sub_u32 s63, s63, 1
    s_cbranch_scc0 L_LW3
L_LW3_out:
    s_mov_b32 s8, s32
    s_mov_b32 s9, s33
    s_mov_b32 s10, 5308416
    s_mov_b32 s11, 0x20000
    s_mul_i32 s56, s96, 36864
    s_mov_b32 m0, 0
    s_mov_b32 s58, 9
L_W9_D:
    s_add_u32 s57, s56, 0
    buffer_load_dwordx4 v10, s[8:11], s57 offen nt lds
    s_add_u32 m0, m0, 1024
    s_add_u32 s57, s56, 9216
    buffer_load_dwordx4 v10, s[8:11], s57 offen nt lds
    s_add_u32 m0, m0, 1024
    s_add_u32 s57, s56, 18432
    buffer_load_dwordx4 v10, s[8:11], s57 offen nt lds
    s_add_u32 m0, m0, 1024
    s_add_u32 s57, s56, 27648
    buffer_load_dwordx4 v10, s[8:11], s57 offen nt lds
    s_add_u32 m0, m0, 1024
    s_add_u32 s56, s56, 128
    s_sub_u32 s58, s58, 1
    s_cmp_lg_u32 s58, 0
    s_cbranch_scc1 L_W9_D
    v_mov_b32 v1, 139288
    v_mov_b32 v2, 1
    ds_write_b32 v1, v2
    s_waitcnt vmcnt(36)
    s_barrier
    s_waitcnt vmcnt(0) lgkmcnt(0)
    s_endpgm
L_W9_X:
    s_mov_b32 s8, s24
    s_mov_b32 s9, s25
    s_mov_b32 s10, 4718592
    s_mov_b32 s11, 0x20000
    v_mul_u32_u24 v10, 1152, v8
    v_add_u32 v10, v10, v9
    s_mul_i32 s52, s97, 6
    s_mov_b32 s53, 6
    s_cmp_lt_u32 s97, 6
    s_cbranch_scc1 L_UN52_1007
    s_sub_u32 s54, s97, 6
    s_mul_i32 s52, s54, 5
    s_add_u32 s52, s52, 36
    s_cmp_lt_u32 s54, 4
    s_cselect_b32 s53, 5, 4
    s_cmp_eq_u32 s54, 5
    s_cselect_b32 s54, 1, 0
    s_sub_u32 s52, s52, s54
L_UN52_1007:
    s_mul_i32 s56, s52, 73728
    s_lshl_b32 s57, s98, 7
    s_add_u32 s56, s56, s57
    s_waitcnt vmcnt(0)
    s_barrier
    s_cmp_eq_u32 s99, 1
    s_cbranch_scc0 L_W9_FIN
    s_mov_b32 m0, 65536
    s_mov_b32 s58, 4
L_W9_OE:
    buffer_load_dwordx4 v10, s[8:11], s56 offen nt lds
    s_add_u32 m0, m0, 1024
    s_add_u32 s56, s56, 9216
    buffer_load_dwordx4 v10, s[8:11], s56 offen nt lds
    s_add_u32 m0, m0, 1024
    s_add_u32 s56, s56, 9216
    buffer_load_dwordx4 v10, s[8:11], s56 offen nt lds
    s_add_u32 m0, m0, 1024
    s_add_u32 s56, s56, 9216
    buffer_load_dwordx4 v10, s[8:11], s56 offen nt lds
    s_add_u32 m0, m0, 1024
    s_add_u32 s56, s56, 9216
    s_sub_u32 s58, s58, 1
    s_cmp_lg_u32 s58, 0
    s_cbranch_scc1 L_W9_OE
    v_mov_b32 v1, 139304
    s_mov_b32 s63, 200000
L_LW4:
    ds_read_b32 v2, v1
    s_waitcnt lgkmcnt(0)
    v_readfirstlane_b32 s61, v2
    s_nop 0
    s_cmp_ge_u32 s61, 1
    s_cbranch_scc1 L_LW4_out
    s_sub_u32 s63, s63, 1
    s_cbranch_scc0 L_LW4
L_LW4_out:
    s_lshl_b32 s58, s53, 1
    s_sub_u32 s58, s58, 4
L_W9_O:
    buffer_load_dwordx4 v10, s[8:11], s56 offen nt lds
    s_add_u32 m0, m0, 1024
    s_add_u32 s56, s56, 9216
    buffer_load_dwordx4 v10, s[8:11], s56 offen nt lds
    s_add_u32 m0, m0, 1024
    s_add_u32 s56, s56, 9216
    buffer_load_dwordx4 v10, s[8:11], s56 offen nt lds
    s_add_u32 m0, m0, 1024
    s_add_u32 s56, s56, 9216
    buffer_load_dwordx4 v10, s[8:11], s56 offen nt lds
    s_add_u32 m0, m0, 1024
    s_add_u32 s56, s56, 9216
    s_sub_u32 s58, s58, 1
    s_cmp_lg_u32 s58, 0
    s_cbranch_scc1 L_W9_O
L_W9_FIN:
    v_mov_b32 v1, 139288
    v_mov_b32 v2, 1
    ds_write_b32 v1, v2
    s_waitcnt vmcnt(0) lgkmcnt(0)
    s_endpgm
L_ROLE:
    s_mov_b32 s62, 200000
    s_mov_b32 s6, s96
    s_mov_b32 s7, s97
    s_mov_b32 s5, s98
    s_mul_i32 s44, s45, 0x9E3779B1
    s_add_u32 s44, s44, 0x85EBCA6B
    s_and_b32 s44, s44, 0xBFFFBFFF
    s_mov_b32 s40, s38
    s_mov_b32 s41, s39
    s_mov_b32 s42, 2097152
    s_mov_b32 s43, 0x20000
    s_cmp_eq_u32 s99, 0
    s_cbranch_scc1 L_Y
    s_cmp_eq_u32 s99, 1
    s_cbranch_scc0 L_RED
    s_mul_i32 s52, s97, 6
    s_mov_b32 s53, 6
    s_cmp_lt_u32 s97, 6
    s_cbranch_scc1 L_UN52_1096
    s_sub_u32 s54, s97, 6
    s_mul_i32 s52, s54, 5
    s_add_u32 s52, s52, 36
    s_cmp_lt_u32 s54, 4
    s_cselect_b32 s53, 5, 4
    s_cmp_eq_u32 s54, 5
    s_cselect_b32 s54, 1, 0
    s_sub_u32 s52, s52, s54
L_UN52_1096:
    s_cmp_ge_u32 s3, s53
    s_cbranch_scc1 L_X_IDLE
    s_add_u32 s58, s52, s3
    s_and_b32 s57, s58, 1
    s_lshr_b32 s58, s58, 1
    s_sub_u32 s51, s53, 1
    v_and_b32 v1, 15, v0
    v_lshrrev_b32 v2, 4, v0
    v_lshlrev_b32 v60, 9, v2
    v_lshl_add_u32 v60, v1, 4, v60
    s_lshl_b32 s59, s58, 13
    s_lshl_b32 s60, s57, 8
    s_add_u32 s59, s59, s60
    s_add_u32 s59, s59, 139264
    v_add_u32 v61, v1, v2
    v_and_b32 v61, 15, v61
    v_lshlrev_b32 v61, 4, v61
    s_lshl_b32 s60, s58, 8
    s_add_u32 s60, s60, 401408
    v_and_b32 v3, 1, v1
    v_lshl_add_u32 v3, v3, 2, v2
    v_lshlrev_b32 v3, 3, v3
    v_lshrrev_b32 v62, 1, v1
    v_add_u32 v3, v3, v62
    s_lshl_b32 s61, s3, 8
    s_add_u32 s61, s61, 159360
    v_lshl_add_u32 v62, v3, 2, s61
    v_lshl_add_u32 v63, v8, 5, s61
    s_lshl_b32 s61, s3, 13
    s_add_u32 s61, s61, 65536
    v_add_u32 v58, s61, v11
    v_and_b32 v59, 7, v1
    v_lshlrev_b32 v59, 5, v59
    v_and_b32 v57, 1, v2
    v_lshl_add_u32 v59, v57, 4, v59
    v_lshrrev_b32 v57, 1, v2
    v_lshl_add_u32 v59, v57, 3, v59
    s_lshl_b32 s61, s3, 8
    s_add_u32 s61, s61, 157056
    v_add_u32 v57, s61, v59
    v_add_u32 v56, 157056, v59
    s_mul_i32 s54, s7, 2304
    s_lshl_b32 s55, s5, 8
    s_add_u32 s54, s54, s55
    s_add_u32 s54, s54, 409600
    v_mov_b32 v54, 139292
    v_mov_b32 v55, 1
    v_mov_b32 v1, 139288
    s_mov_b32 s63, 200000
L_LW5:
    ds_read_b32 v2, v1
    s_waitcnt lgkmcnt(0)
    v_readfirstlane_b32 s61, v2
    s_nop 0
    s_cmp_ge_u32 s61, 1
    s_cbranch_scc1 L_LW5_out
    s_sub_u32 s63, s63, 1
    s_cbranch_scc0 L_LW5
L_LW5_out:
    s_add_u32 s48, s59, 2048
    s_add_u32 s49, s59, 4096
    s_add_u32 s50, s59, 6144
    buffer_load_dwordx4 v[64:67], v61, s[40:43], s60 offen sc1
    buffer_load_dwordx4 v[68:71], v60, s[40:43], s59 offen sc1
    buffer_load_dwordx4 v[72:75], v60, s[40:43], s48 offen sc1
    buffer_load_dwordx4 v[76:79], v60, s[40:43], s49 offen sc1
    buffer_load_dwordx4 v[80:83], v60, s[40:43], s50 offen sc1
    s_barrier
    ds_read_b128 v[136:139], v58 offset:0
    ds_read_b128 v[140:143], v58 offset:1024
    ds_read_b128 v[144:147], v58 offset:2048
    ds_read_b128 v[148:151], v58 offset:3072
    ds_read_b128 v[152:155], v58 offset:4096
    ds_read_b128 v[156:159], v58 offset:5120
    ds_read_b128 v[160:163], v58 offset:6144
    ds_read_b128 v[164:167], v58 offset:7168
L_XG:
    s_waitcnt vmcnt(0)
    v_bitop3_b32 v96, v65, v67, s44 bitop3:0x7e
    v_cmp_ne_u32 s[64:65], 0, v96
    v_bitop3_b32 v97, v69, v71, s44 bitop3:0x7e
    v_cmp_ne_u32 s[66:67], 0, v97
    v_bitop3_b32 v96, v73, v75, s44 bitop3:0x7e
    v_cmp_ne_u32 s[68:69], 0, v96
    v_bitop3_b32 v97, v77, v79, s44 bitop3:0x7e
    v_cmp_ne_u32 s[70:71], 0, v97
    v_bitop3_b32 v96, v81, v83, s44 bitop3:0x7e
    v_cmp_ne_u32 s[72:73], 0, v96
    s_or_b64 vcc, s[64:65], s[66:67]
    s_or_b64 vcc, vcc, s[68:69]
    s_or_b64 vcc, vcc, s[70:71]
    s_or_b64 vcc, vcc, s[72:73]
    s_cbranch_scc0 L_XG_out
    s_sub_u32 s62, s62, 1
    s_cbranch_scc1 L_XG_out
    s_mov_b64 exec, s[64:65]
    s_cbranch_execz L_XG_k0
    buffer_load_dwordx4 v[64:67], v61, s[40:43], s60 offen sc1
L_XG_k0:
    s_mov_b64 exec, s[66:67]
    s_cbranch_execz L_XG_k1
    buffer_load_dwordx4 v[68:71], v60, s[40:43], s59 offen sc1
L_XG_k1:
    s_mov_b64 exec, s[68:69]
    s_cbranch_execz L_XG_k2
    buffer_load_dwordx4 v[72:75], v60, s[40:43], s48 offen sc1
L_XG_k2:
    s_mov_b64 exec, s[70:71]
    s_cbranch_execz L_XG_k3
    buffer_load_dwordx4 v[76:79], v60, s[40:43], s49 offen sc1
L_XG_k3:
    s_mov_b64 exec, s[72:73]
    s_cbranch_execz L_XG_k4
    buffer_load_dwordx4 v[80:83], v60, s[40:43], s50 offen sc1
L_XG_k4:
    s_mov_b64 exec, -1
    s_branch L_XG
L_XG_out:
    v_mov_b32 v84, v64
    v_lshlrev_b32 v104, 16, v68
    v_and_b32 v105, 0xffff0000, v68
    v_max_f32_dpp v84, v84, v84 quad_perm:[1,0,3,2] row_mask:0xf bank_mask:0xf
    v_lshlrev_b32 v106, 16, v70
    v_and_b32 v107, 0xffff0000, v70
    v_lshlrev_b32 v108, 16, v72
    v_and_b32 v109, 0xffff0000, v72
    v_max_f32_dpp v84, v84, v84 quad_perm:[2,3,0,1] row_mask:0xf bank_mask:0xf
    v_lshlrev_b32 v110, 16, v74
    v_and_b32 v111, 0xffff0000, v74
    v_lshlrev_b32 v112, 16, v76
    v_and_b32 v113, 0xffff0000, v76
    v_max_f32_dpp v84, v84, v84 row_ror:4 row_mask:0xf bank_mask:0xf
    v_lshlrev_b32 v114, 16, v78
    v_and_b32 v115, 0xffff0000, v78
    v_lshlrev_b32 v116, 16, v80
    v_and_b32 v117, 0xffff0000, v80
    v_max_f32_dpp v84, v84, v84 row_ror:8 row_mask:0xf bank_mask:0xf
    v_lshlrev_b32 v118, 16, v82
    v_and_b32 v119, 0xffff0000, v82
    v_sub_f32 v84, v64, v84
    v_mul_f32 v84, 0x3fb8aa3b, v84
    v_exp_f32 v84, v84
    v_mov_b32 v92, 0
    v_mov_b32 v93, 0
    v_mul_f32 v85, v84, v66
    v_mov_b32 v94, 0
    v_mov_b32 v95, 0
    v_add_f32_dpp v85, v85, v85 quad_perm:[1,0,3,2] row_mask:0xf bank_mask:0xf
    v_fmac_f32_dpp v92, v84, v104 row_newbcast:0 row_mask:0xf bank_mask:0xf
    v_fmac_f32_dpp v93, v84, v105 row_newbcast:0 row_mask:0xf bank_mask:0xf
    v_fmac_f32_dpp v94, v84, v106 row_newbcast:0 row_mask:0xf bank_mask:0xf
    v_fmac_f32_dpp v95, v84, v107 row_newbcast:0 row_mask:0xf bank_mask:0xf
    v_add_f32_dpp v85, v85, v85 quad_perm:[2,3,0,1] row_mask:0xf bank_mask:0xf
    v_fmac_f32_dpp v92, v84, v108 row_newbcast:4 row_mask:0xf bank_mask:0xf
    v_fmac_f32_dpp v93, v84, v109 row_newbcast:4 row_mask:0xf bank_mask:0xf
    v_fmac_f32_dpp v94, v84, v110 row_newbcast:4 row_mask:0xf bank_mask:0xf
    v_fmac_f32_dpp v95, v84, v111 row_newbcast:4 row_mask:0xf bank_mask:0xf
    v_add_f32_dpp v85, v85, v85 row_ror:4 row_mask:0xf bank_mask:0xf
    v_fmac_f32_dpp v92, v84, v112 row_newbcast:8 row_mask:0xf bank_mask:0xf
    v_fmac_f32_dpp v93, v84, v113 row_newbcast:8 row_mask:0xf bank_mask:0xf
    v_fmac_f32_dpp v94, v84, v114 row_newbcast:8 row_mask:0xf bank_mask:0xf
    v_fmac_f32_dpp v95, v84, v115 row_newbcast:8 row_mask:0xf bank_mask:0xf
    v_add_f32_dpp v85, v85, v85 row_ror:8 row_mask:0xf bank_mask:0xf
    v_fmac_f32_dpp v92, v84, v116 row_newbcast:12 row_mask:0xf bank_mask:0xf
    v_fmac_f32_dpp v93, v84, v117 row_newbcast:12 row_mask:0xf bank_mask:0xf
    v_fmac_f32_dpp v94, v84, v118 row_newbcast:12 row_mask:0xf bank_mask:0xf
    v_fmac_f32_dpp v95, v84, v119 row_newbcast:12 row_mask:0xf bank_mask:0xf
    v_rcp_f32 v85, v85
    v_permlane32_swap_b32 v92, v94
    v_permlane32_swap_b32 v93, v95
    v_add_f32 v92, v92, v94
    v_add_f32 v93, v93, v95
    s_nop 1
    v_permlane16_swap_b32 v92, v93
    v_add_f32 v92, v92, v93
    v_mul_f32 v92, v92, v85
    v_cvt_pk_bf16_f32 v92, v92, v92
    ds_write_b32 v62, v92
    s_waitcnt lgkmcnt(0)
    ds_read_b128 v[124:127], v63
    ds_read_b128 v[128:131], v63 offset:16
    s_waitcnt lgkmcnt(0)
    v_and_b32 v40, v124, v4
    v_and_b32 v41, v124, v5
    v_and_b32 v42, v124, v6
    v_and_b32 v43, v124, v7
    v_and_b32 v44, v125, v4
    v_and_b32 v45, v125, v5
    v_and_b32 v46, v125, v6
    v_and_b32 v47, v125, v7
    v_mfma_f32_16x16x32_bf16 v[132:135], v[40:43], v[136:139], 0
    v_and_b32 v40, v126, v4
    v_and_b32 v41, v126, v5
    v_and_b32 v42, v126, v6
    v_and_b32 v43, v126, v7
    v_mfma_f32_16x16x32_bf16 v[132:135], v[44:47], v[140:143], v[132:135]
    v_and_b32 v44, v127, v4
    v_and_b32 v45, v127, v5
    v_and_b32 v46, v127, v6
    v_and_b32 v47, v127, v7
    v_mfma_f32_16x16x32_bf16 v[132:135], v[40:43], v[144:147], v[132:135]
    v_and_b32 v40, v128, v4
    v_and_b32 v41, v128, v5
    v_and_b32 v42, v128, v6
    v_and_b32 v43, v128, v7
    v_mfma_f32_16x16x32_bf16 v[132:135], v[44:47], v[148:151], v[132:135]
    v_and_b32 v44, v129, v4
    v_and_b32 v45, v129, v5
    v_and_b32 v46, v129, v6
    v_and_b32 v47, v129, v7
    v_mfma_f32_16x16x32_bf16 v[132:135], v[40:43], v[152:155], v[132:135]
    v_and_b32 v40, v130, v4
    v_and_b32 v41, v130, v5
    v_and_b32 v42, v130, v6
    v_and_b32 v43, v130, v7
    v_mfma_f32_16x16x32_bf16 v[132:135], v[44:47], v[156:159], v[132:135]
    v_and_b32 v44, v131, v4
    v_and_b32 v45, v131, v5
    v_and_b32 v46, v131, v6
    v_and_b32 v47, v131, v7
    v_mfma_f32_16x16x32_bf16 v[132:135], v[40:43], v[160:163], v[132:135]
    s_nop 0
    v_mfma_f32_16x16x32_bf16 v[132:135], v[44:47], v[164:167], v[132:135]
    s_nop 7
    v_permlane32_swap_b32 v132, v134
    v_permlane32_swap_b32 v133, v135
    s_nop 0
    v_add_f32_dpp v132, v134, v132 row_ror:8 row_mask:0xf bank_mask:0xf
    v_add_f32_dpp v133, v135, v133 row_ror:8 row_mask:0xf bank_mask:0xf
    s_mov_b32 s56, 0x00ff00ff
    s_mov_b32 s57, 0x00ff00ff
    s_mov_b64 exec, s[56:57]
    ds_write_b64 v57, v[132:133]
    s_mov_b64 exec, 1
    ds_add_rtn_u32 v55, v54, v55
    s_mov_b64 exec, -1
    s_waitcnt lgkmcnt(0)
    v_readfirstlane_b32 s61, v55
    s_nop 0
    s_cmp_eq_u32 s61, s51
    s_cbranch_scc0 L_X_DONE
    ds_read_b64 v[136:137], v56 offset:0
    ds_read_b64 v[138:139], v56 offset:256
    ds_read_b64 v[140:141], v56 offset:512
    ds_read_b64 v[142:143], v56 offset:768
    ds_read_b64 v[144:145], v56 offset:1024
    ds_read_b64 v[146:147], v56 offset:1280
    v_mov_b32 v85, s44
    s_waitcnt lgkmcnt(0)
    v_pk_add_f32 v[136:137], v[136:137], v[138:139]
    v_pk_add_f32 v[140:141], v[140:141], v[142:143]
    v_pk_add_f32 v[136:137], v[136:137], v[140:141]
    s_cmp_lt_u32 s53, 5
    s_cbranch_scc1 L_X_SUMD
    v_pk_add_f32 v[136:137], v[136:137], v[144:145]
    s_cmp_lt_u32 s53, 6
    s_cbranch_scc1 L_X_SUMD
    v_pk_add_f32 v[136:137], v[136:137], v[146:147]
L_X_SUMD:
    v_cvt_pk_bf16_f32 v84, v136, v137
    s_mov_b64 exec, s[56:57]
    buffer_store_dwordx2 v[84:85], v59, s[40:43], s54 offen sc1
    s_mov_b64 exec, -1
    s_branch L_X_DONE
L_X_IDLE:
    s_barrier
L_X_DONE:
    s_branch L_RED
L_Y:
    s_mov_b32 s12, s16
    s_mov_b32 s13, s17
    s_mov_b32 s14, 1152
    s_mov_b32 s15, 0x20000
    v_and_b32 v1, 15, v0
    v_lshrrev_b32 v2, 4, v0
    v_and_b32 v3, 1, v2
    v_lshlrev_b32 v3, 1, v3
    v_lshrrev_b32 v16, 1, v2
    v_add_u32 v23, v3, v16
    v_lshl_add_u32 v3, v1, 2, v23
    s_lshl_b32 s56, s3, 6
    v_add_u32 v16, s56, v3
    v_lshlrev_b32 v17, 1, v16
    buffer_load_ushort v18, v17, s[12:15], 0 offen
    v_mul_u32_u24 v17, 911, v16
    v_lshrrev_b32 v17, 16, v17
    v_mul_u32_u24 v19, 72, v17
    v_sub_u32 v19, v16, v19
    v_mul_u32_u24 v17, 96, v17
    v_lshrrev_b32 v20, 3, v19
    v_add_u32 v17, v17, v20
    v_and_b32 v19, 7, v19
    v_mul_u32_u24 v19, 12, v19
    v_add_u32 v17, v17, v19
    v_lshlrev_b32 v17, 2, v17
    v_add_u32 v17, 151552, v17
    v_lshlrev_b32 v35, 2, v16
    v_add_u32 v35, 154752, v35
    s_mul_i32 s56, s3, 384
    s_add_u32 s56, s56, 151552
    v_mul_u32_u24 v19, 48, v8
    v_add_u32 v19, s56, v19
    v_and_b32 v20, 4, v0
    v_mul_u32_u24 v20, 9216, v20
    v_lshl_add_u32 v20, v8, 6, v20
    v_and_b32 v21, 3, v0
    v_lshl_add_u32 v20, v21, 4, v20
    s_mul_i32 s56, s3, 4608
    s_add_u32 s56, s56, 65536
    v_add_u32 v20, s56, v20
    s_lshl_b32 s56, s3, 12
    v_add_u32 v21, s56, v11
    v_mul_u32_u24 v24, 2304, v2
    v_lshl_add_u32 v24, v1, 4, v24
    v_mov_b32 v25, v24
    s_lshl_b32 s56, s3, 8
    s_add_u32 s56, s56, 409600
    s_add_u32 s57, s56, 9216
    s_add_u32 s58, s56, 18432
    v_and_b32 v26, 7, v1
    v_lshlrev_b32 v26, 5, v26
    v_and_b32 v27, 1, v2
    v_lshl_add_u32 v26, v27, 4, v26
    v_lshrrev_b32 v27, 1, v2
    v_lshl_add_u32 v26, v27, 8, v26
    s_lshl_b32 s59, s3, 9
    s_add_u32 s59, s59, 139520
    v_add_u32 v27, s59, v26
    v_and_b32 v28, 7, v0
    v_lshlrev_b32 v28, 2, v28
    v_add_u32 v28, v28, v8
    v_lshlrev_b32 v28, 2, v28
    v_add_u32 v28, 154624, v28
    v_lshlrev_b32 v29, 4, v8
    v_add_u32 v29, 154624, v29
    v_and_b32 v30, 3, v1
    v_lshlrev_b32 v30, 5, v30
    v_and_b32 v31, 1, v2
    v_lshl_add_u32 v30, v31, 4, v30
    v_lshrrev_b32 v31, 1, v2
    v_lshl_add_u32 v30, v31, 3, v30
    v_bfe_u32 v31, v1, 2, 1
    v_mul_u32_u24 v31, 18432, v31
    v_add_u32 v30, v30, v31
    s_mul_i32 s54, s3, 36864
    s_lshl_b32 s55, s6, 7
    s_add_u32 s54, s54, s55
    s_add_u32 s54, s54, 442368
    v_lshlrev_b32 v31, 2, v0
    v_add_u32 v22, 154752, v31
    v_add_u32 v31, 139520, v31
    v_and_b32 v48, 0x3f803f80, v4
    v_and_b32 v49, 0x3f803f80, v5
    v_and_b32 v50, 0x3f803f80, v6
    v_and_b32 v51, 0x3f803f80, v7
    s_mov_b32 s48, 0
    s_mov_b32 s49, -1
    v_mov_b32 v32, 139288
    s_mov_b32 s63, 200000
L_LW6:
    ds_read_b32 v33, v32
    s_waitcnt lgkmcnt(0)
    v_readfirstlane_b32 s61, v33
    s_nop 0
    s_cmp_ge_u32 s61, 1
    s_cbranch_scc1 L_LW6_out
    s_sub_u32 s63, s63, 1
    s_cbranch_scc0 L_LW6
L_LW6_out:
    buffer_load_dwordx4 v[52:55], v24, s[40:43], s56 offen sc1
    buffer_load_dwordx4 v[56:59], v24, s[40:43], s57 offen sc1
    buffer_load_dwordx4 v[60:63], v25, s[40:43], s58 offen sc1
    s_barrier
    s_cmp_eq_u32 s3, 8
    s_cbranch_scc1 L_Y_NOCS
    ds_read_b128 v[132:135], v20 offset:0
    ds_read_b128 v[136:139], v20 offset:512
    ds_read_b128 v[140:143], v20 offset:1024
    ds_read_b128 v[144:147], v20 offset:1536
    ds_read_b128 v[148:151], v20 offset:2048
    ds_read_b128 v[152:155], v20 offset:2560
    ds_read_b128 v[156:159], v20 offset:3072
    ds_read_b128 v[160:163], v20 offset:3584
    ds_read_b128 v[164:167], v20 offset:4096
    s_waitcnt lgkmcnt(8)
    v_mfma_f32_16x16x32_bf16 v[112:115], v[48:51], v[132:135], 0
    s_waitcnt lgkmcnt(7)
    v_mfma_f32_16x16x32_bf16 v[112:115], v[48:51], v[136:139], v[112:115]
    s_waitcnt lgkmcnt(6)
    v_mfma_f32_16x16x32_bf16 v[112:115], v[48:51], v[140:143], v[112:115]
    s_waitcnt lgkmcnt(5)
    v_mfma_f32_16x16x32_bf16 v[112:115], v[48:51], v[144:147], v[112:115]
    s_waitcnt lgkmcnt(4)
    v_mfma_f32_16x16x32_bf16 v[112:115], v[48:51], v[148:151], v[112:115]
    s_waitcnt lgkmcnt(3)
    v_mfma_f32_16x16x32_bf16 v[112:115], v[48:51], v[152:155], v[112:115]
    s_waitcnt lgkmcnt(2)
    v_mfma_f32_16x16x32_bf16 v[112:115], v[48:51], v[156:159], v[112:115]
    s_waitcnt lgkmcnt(1)
    v_mfma_f32_16x16x32_bf16 v[112:115], v[48:51], v[160:163], v[112:115]
    s_waitcnt lgkmcnt(0)
    v_mfma_f32_16x16x32_bf16 v[112:115], v[48:51], v[164:167], v[112:115]
    s_mov_b32 exec_lo, 0x00ff00ff
    s_mov_b32 exec_hi, 0xff00ff00
    s_nop 5
    ds_write_b128 v27, v[112:115] offset:4096
    s_mov_b64 exec, -1
L_Y_NOCS:
L_YG:
    s_waitcnt vmcnt(0)
    v_mfma_f32_16x16x32_bf16 v[92:95], v[48:51], v[52:55], 0
    v_mfma_f32_16x16x32_bf16 v[92:95], v[48:51], v[56:59], v[92:95]
    v_mfma_f32_16x16x32_bf16 v[92:95], v[48:51], v[60:63], v[92:95]
    v_bitop3_b32 v96, v53, v55, s44 bitop3:0x7e
    v_cmp_ne_u32 s[64:65], 0, v96
    v_bitop3_b32 v97, v57, v59, s44 bitop3:0x7e
    v_cmp_ne_u32 s[66:67], 0, v97
    v_bitop3_b32 v96, v61, v63, s44 bitop3:0x7e
    v_cmp_ne_u32 s[68:69], 0, v96
    s_or_b64 vcc, s[64:65], s[66:67]
    s_or_b64 vcc, vcc, s[68:69]
    s_cbranch_scc0 L_YG_out
    s_sub_u32 s62, s62, 1
    s_cbranch_scc1 L_YG_out
    s_mov_b64 exec, s[64:65]
    s_cbranch_execz L_YG_k0
    buffer_load_dwordx4 v[52:55], v24, s[40:43], s56 offen sc1
L_YG_k0:
    s_mov_b64 exec, s[66:67]
    s_cbranch_execz L_YG_k1
    buffer_load_dwordx4 v[56:59], v24, s[40:43], s57 offen sc1
L_YG_k1:
    s_mov_b64 exec, s[68:69]
    s_cbranch_execz L_YG_k2
    buffer_load_dwordx4 v[60:63], v25, s[40:43], s58 offen sc1
L_YG_k2:
    s_mov_b64 exec, -1
    s_branch L_YG
L_YG_out:
    v_lshlrev_b32 v18, 16, v18
    v_cndmask_b32 v96, v92, v93, s[48:49]
    v_cvt_pk_bf16_f32 v96, v96, v96
    v_lshlrev_b32 v96, 16, v96
    v_add_f32 v96, v96, v18
    v_cvt_pk_bf16_f32 v96, v96, v96
    ds_write_b32 v17, v96
    v_and_b32 v97, 0xffff0000, v96
    ds_write_b32 v35, v97
    s_waitcnt lgkmcnt(0)
    s_barrier
    s_cmp_eq_u32 s3, 8
    s_cbranch_scc1 L_Y_STAT
    ds_read_b128 v[96:99], v19
    ds_read_b128 v[100:103], v19 offset:16
    ds_read_b32 v104, v19 offset:32
    ds_read_b128 v[64:67], v21 offset:0
    ds_read_b128 v[68:71], v21 offset:1024
    ds_read_b128 v[72:75], v21 offset:2048
    ds_read_b128 v[76:79], v21 offset:3072
    s_waitcnt lgkmcnt(6)
    v_and_b32 v108, v96, v4
    v_and_b32 v109, v96, v5
    v_and_b32 v110, v96, v6
    v_and_b32 v111, v96, v7
    v_and_b32 v116, v97, v4
    v_and_b32 v117, v97, v5
    v_and_b32 v118, v97, v6
    v_and_b32 v119, v97, v7
    v_mfma_f32_16x16x32_bf16 v[112:115], v[108:111], v[132:135], 0
    v_and_b32 v108, v98, v4
    v_and_b32 v109, v98, v5
    v_and_b32 v110, v98, v6
    v_and_b32 v111, v98, v7
    v_mfma_f32_16x16x32_bf16 v[112:115], v[116:119], v[136:139], v[112:115]
    v_and_b32 v116, v99, v4
    v_and_b32 v117, v99, v5
    v_and_b32 v118, v99, v6
    v_and_b32 v119, v99, v7
    v_mfma_f32_16x16x32_bf16 v[112:115], v[108:111], v[140:143], v[112:115]
    s_waitcnt lgkmcnt(5)
    v_and_b32 v108, v100, v4
    v_and_b32 v109, v100, v5
    v_and_b32 v110, v100, v6
    v_and_b32 v111, v100, v7
    v_mfma_f32_16x16x32_bf16 v[112:115], v[116:119], v[144:147], v[112:115]
    v_and_b32 v116, v101, v4
    v_and_b32 v117, v101, v5
    v_and_b32 v118, v101, v6
    v_and_b32 v119, v101, v7
    v_mfma_f32_16x16x32_bf16 v[112:115], v[108:111], v[148:151], v[112:115]
    v_and_b32 v108, v102, v4
    v_and_b32 v109, v102, v5
    v_and_b32 v110, v102, v6
    v_and_b32 v111, v102, v7
    v_mfma_f32_16x16x32_bf16 v[112:115], v[116:119], v[152:155], v[112:115]
    v_and_b32 v116, v103, v4
    v_and_b32 v117, v103, v5
    v_and_b32 v118, v103, v6
    v_and_b32 v119, v103, v7
    v_mfma_f32_16x16x32_bf16 v[112:115], v[108:111], v[156:159], v[112:115]
    s_waitcnt lgkmcnt(4)
    v_and_b32 v108, v104, v4
    v_and_b32 v109, v104, v5
    v_and_b32 v110, v104, v6
    v_and_b32 v111, v104, v7
    v_mfma_f32_16x16x32_bf16 v[112:115], v[116:119], v[160:163], v[112:115]
    s_nop 0
    v_mfma_f32_16x16x32_bf16 v[112:115], v[108:111], v[164:167], v[112:115]
    s_mov_b32 exec_lo, 0x00ff00ff
    s_mov_b32 exec_hi, 0xff00ff00
    s_nop 5
    ds_write_b128 v27, v[112:115]
    s_mov_b64 exec, -1
    s_waitcnt lgkmcnt(0)
    s_barrier
    s_barrier
    s_branch L_Y_DOWN
L_Y_STAT:
    v_lshlrev_b32 v2, 5, v0
    v_add_u32 v2, 154752, v2
    ds_read_b128 v[96:99], v2
    ds_read_b128 v[100:103], v2 offset:16
    ds_read_b32 v104, v22 offset:2048
    ds_read2st64_b32 v[136:137], v31 offset0:16 offset1:17
    ds_read2st64_b32 v[138:139], v31 offset0:18 offset1:19
    ds_read2st64_b32 v[140:141], v31 offset0:20 offset1:21
    ds_read2st64_b32 v[142:143], v31 offset0:22 offset1:23
    ds_read2st64_b32 v[144:145], v31 offset0:24 offset1:25
    ds_read2st64_b32 v[146:147], v31 offset0:26 offset1:27
    ds_read2st64_b32 v[148:149], v31 offset0:28 offset1:29
    ds_read2st64_b32 v[150:151], v31 offset0:30 offset1:31
    ds_read_b128 v[64:67], v21 offset:0
    ds_read_b128 v[68:71], v21 offset:1024
    ds_read_b128 v[72:75], v21 offset:2048
    ds_read_b128 v[76:79], v21 offset:3072
    s_waitcnt lgkmcnt(12)
    v_pk_add_f32 v[106:107], v[96:97], v[98:99]
    v_pk_mul_f32 v[108:109], v[96:97], v[96:97]
    v_pk_add_f32 v[106:107], v[106:107], v[100:101]
    v_pk_fma_f32 v[108:109], v[98:99], v[98:99], v[108:109]
    v_pk_add_f32 v[106:107], v[106:107], v[102:103]
    v_pk_fma_f32 v[108:109], v[100:101], v[100:101], v[108:109]
    v_add_f32 v106, v106, v104
    v_pk_fma_f32 v[108:109], v[102:103], v[102:103], v[108:109]
    v_add_f32 v106, v106, v107
    v_fmac_f32 v108, v104, v104
    v_add_f32 v108, v108, v109
    v_add_f32_dpp v106, v106, v106 quad_perm:[1,0,3,2] row_mask:0xf bank_mask:0xf
    s_nop 0
    v_add_f32_dpp v108, v108, v108 quad_perm:[1,0,3,2] row_mask:0xf bank_mask:0xf
    v_add_f32_dpp v106, v106, v106 quad_perm:[2,3,0,1] row_mask:0xf bank_mask:0xf
    s_nop 0
    v_add_f32_dpp v108, v108, v108 quad_perm:[2,3,0,1] row_mask:0xf bank_mask:0xf
    v_add_f32_dpp v106, v106, v106 row_ror:4 row_mask:0xf bank_mask:0xf
    s_nop 0
    v_add_f32_dpp v108, v108, v108 row_ror:4 row_mask:0xf bank_mask:0xf
    v_add_f32_dpp v106, v106, v106 row_ror:8 row_mask:0xf bank_mask:0xf
    s_nop 0
    v_add_f32_dpp v108, v108, v108 row_ror:8 row_mask:0xf bank_mask:0xf
    v_mov_b32 v110, v106
    v_mov_b32 v111, v108
    s_nop 0
    v_permlane16_swap_b32 v110, v106
    v_permlane16_swap_b32 v111, v108
    v_add_f32 v106, v106, v110
    v_add_f32 v108, v108, v111
    v_mov_b32 v110, v106
    v_mov_b32 v111, v108
    s_nop 0
    v_permlane32_swap_b32 v110, v106
    v_permlane32_swap_b32 v111, v108
    v_add_f32 v106, v106, v110
    v_add_f32 v108, v108, v111
    v_mul_f32 v106, 0x3ae38e39, v106
    v_mul_f32 v108, 0x3ae38e39, v108
    v_fma_f32 v108, -v106, v106, v108
    v_max_f32 v108, 0, v108
    v_cvt_pk_bf16_f32 v94, v106, v106
    v_lshlrev_b32 v94, 16, v94
    v_cvt_pk_bf16_f32 v91, v108, v108
    v_lshlrev_b32 v91, 16, v91
    v_add_f32 v91, 0x3727c5ac, v91
    v_cvt_pk_bf16_f32 v91, v91, v91
    v_lshlrev_b32 v91, 16, v91
    v_sqrt_f32 v91, v91
    s_nop 0
    v_cvt_pk_bf16_f32 v91, v91, v91
    v_lshlrev_b32 v91, 16, v91
    v_rcp_f32 v92, v91
    s_waitcnt lgkmcnt(4)
    v_pk_add_f32 v[136:137], v[136:137], v[138:139]
    v_pk_add_f32 v[136:137], v[136:137], v[140:141]
    v_pk_add_f32 v[136:137], v[136:137], v[142:143]
    v_pk_add_f32 v[136:137], v[136:137], v[144:145]
    v_pk_add_f32 v[136:137], v[136:137], v[146:147]
    v_pk_add_f32 v[136:137], v[136:137], v[148:149]
    v_pk_add_f32 v[136:137], v[136:137], v[150:151]
    v_add_f32 v136, v136, v137
    v_mul_f32 v95, v136, v94
    s_barrier
    ds_read2st64_b32 v[136:137], v31 offset0:0 offset1:1
    ds_read2st64_b32 v[138:139], v31 offset0:2 offset1:3
    ds_read2st64_b32 v[140:141], v31 offset0:4 offset1:5
    ds_read2st64_b32 v[142:143], v31 offset0:6 offset1:7
    ds_read2st64_b32 v[144:145], v31 offset0:8 offset1:9
    ds_read2st64_b32 v[146:147], v31 offset0:10 offset1:11
    ds_read2st64_b32 v[148:149], v31 offset0:12 offset1:13
    ds_read2st64_b32 v[150:151], v31 offset0:14 offset1:15
    s_waitcnt lgkmcnt(0)
    v_pk_add_f32 v[136:137], v[136:137], v[138:139]
    v_pk_add_f32 v[140:141], v[140:141], v[142:143]
    v_pk_add_f32 v[144:145], v[144:145], v[146:147]
    v_pk_add_f32 v[148:149], v[148:149], v[150:151]
    v_pk_add_f32 v[136:137], v[136:137], v[140:141]
    v_pk_add_f32 v[144:145], v[144:145], v[148:149]
    v_pk_add_f32 v[136:137], v[136:137], v[144:145]
    v_add_f32 v80, v136, v137
    v_sub_f32 v80, v80, v95
    v_mul_f32 v80, v80, v92
    v_cvt_pk_bf16_f32 v80, v80, v80
    v_lshlrev_b32 v80, 16, v80
    v_mov_b32 v81, v80
    s_nop 1
    v_permlane32_swap_b32 v80, v81
    v_mul_f32 v82, v80, v80
    v_mul_f32 v82, 0x3d372713, v82
    v_add_f32 v82, 1.0, v82
    v_mul_f32 v82, v82, v80
    v_mul_f32 v82, 0xc0135761, v82
    v_exp_f32 v82, v82
    s_nop 0
    v_add_f32 v82, 1.0, v82
    v_rcp_f32 v82, v82
    s_nop 0
    v_mul_f32 v82, v82, v80
    v_cvt_pk_bf16_f32 v82, v82, v82
    v_lshlrev_b32 v82, 16, v82
    v_mul_f32 v82, v82, v81
    v_cvt_pk_bf16_f32 v82, v82, v82
    s_mov_b32 exec_lo, -1
    s_mov_b32 exec_hi, 0
    ds_write_b32 v28, v82
    s_mov_b64 exec, -1
    s_waitcnt lgkmcnt(0)
    s_barrier
L_Y_DOWN:
    ds_read_b128 v[84:87], v29
    s_waitcnt lgkmcnt(0)
    v_and_b32 v104, v84, v4
    v_and_b32 v105, v84, v5
    v_and_b32 v106, v84, v6
    v_and_b32 v107, v84, v7
    v_and_b32 v108, v85, v4
    v_and_b32 v109, v85, v5
    v_and_b32 v110, v85, v6
    v_and_b32 v111, v85, v7
    v_mfma_f32_16x16x32_bf16 v[112:115], v[104:107], v[64:67], 0
    v_and_b32 v104, v86, v4
    v_and_b32 v105, v86, v5
    v_and_b32 v106, v86, v6
    v_and_b32 v107, v86, v7
    v_mfma_f32_16x16x32_bf16 v[112:115], v[108:111], v[68:71], v[112:115]
    v_and_b32 v108, v87, v4
    v_and_b32 v109, v87, v5
    v_and_b32 v110, v87, v6
    v_and_b32 v111, v87, v7
    v_mfma_f32_16x16x32_bf16 v[112:115], v[104:107], v[72:75], v[112:115]
    s_nop 0
    v_mfma_f32_16x16x32_bf16 v[112:115], v[108:111], v[76:79], v[112:115]
    v_mov_b32 v85, s44
    s_mov_b32 s58, 0x00ff00ff
    s_mov_b32 s59, 0x00ff00ff
    s_nop 4
    v_permlane32_swap_b32 v112, v114
    v_permlane32_swap_b32 v113, v115
    s_nop 0
    v_add_f32_dpp v112, v114, v112 row_ror:8 row_mask:0xf bank_mask:0xf
    v_add_f32_dpp v113, v115, v113 row_ror:8 row_mask:0xf bank_mask:0xf
    v_cvt_pk_bf16_f32 v84, v112, v113
    s_mov_b64 exec, s[58:59]
    buffer_store_dwordx2 v[84:85], v30, s[40:43], s54 offen sc1
    s_mov_b64 exec, -1
    s_cmp_eq_u32 s6, 0
    s_cbranch_scc0 L_FIN
    s_cmp_eq_u32 s3, 8
    s_cbranch_scc0 L_FIN
    s_add_u32 s45, s45, 1
    v_mov_b32 v3, s45
    v_mov_b32 v2, 0
    s_mov_b64 exec, 1
    buffer_store_dword v3, v2, s[40:43], 0 offen sc1
    s_mov_b64 exec, -1
    s_branch L_FIN
L_RED:
    s_cmp_eq_u32 s99, 1
    s_cbranch_scc0 L_FIN
    s_cmp_lt_u32 s97, 10
    s_cbranch_scc1 L_FIN
    s_sub_u32 s6, s97, 10
    s_mul_i32 s6, s6, 9
    s_add_u32 s6, s6, s98
    s_mov_b32 s62, 200000
    s_mul_i32 s56, s6, 18432
    s_lshl_b32 s57, s3, 11
    s_add_u32 s56, s56, s57
    s_add_u32 s56, s56, 442368
    s_add_u32 s57, s56, 1024
    v_and_b32 v1, 7, v0
    v_bfe_u32 v2, v0, 4, 1
    v_lshlrev_b32 v3, 4, v1
    v_lshl_add_u32 v26, v2, 3, v3
    s_lshl_b32 s58, s3, 7
    s_add_u32 s58, s58, 157056
    v_add_u32 v27, s58, v26
    s_mov_b32 s52, 0x00ff00ff
    s_mov_b32 s53, 0
    v_and_b32 v48, 0x3f803f80, v4
    v_and_b32 v49, 0x3f803f80, v5
    v_and_b32 v50, 0x3f803f80, v6
    v_and_b32 v51, 0x3f803f80, v7
    s_mov_b32 s12, s16
    s_mov_b32 s13, s17
    s_mov_b32 s14, 1152
    s_mov_b32 s15, 0x20000
    s_mov_b32 s8, s34
    s_mov_b32 s9, s35
    s_mov_b32 s10, 1152
    s_mov_b32 s11, 0x20000
    s_lshl_b32 s58, s6, 6
    v_lshrrev_b32 v25, 1, v26
    v_add_u32 v25, s58, v25
    s_cmp_eq_u32 s3, 0
    s_cbranch_scc0 L_RG0
    buffer_load_dword v18, v25, s[12:15], 0 offen
    v_mul_u32_u24 v24, 2304, v8
    v_add_u32 v24, v24, v3
    v_cmp_gt_u32 s[46:47], 4, v8
    v_mov_b32 v3, 0x7fffffff
    s_nop 0
    v_cndmask_b32 v23, v3, v24, s[46:47]
    s_lshl_b32 s58, s6, 7
    s_add_u32 s58, s58, 409600
    s_add_u32 s59, s58, 18432
L_RH:
    buffer_load_dwordx4 v[80:83], v24, s[40:43], s58 offen sc1
    buffer_load_dwordx4 v[84:87], v23, s[40:43], s59 offen sc1
    s_waitcnt vmcnt(0)
    v_mfma_f32_16x16x32_bf16 v[92:95], v[48:51], v[80:83], 0
    v_mfma_f32_16x16x32_bf16 v[92:95], v[48:51], v[84:87], v[92:95]
    v_bitop3_b32 v96, v81, v83, s44 bitop3:0x7e
    v_bitop3_b32 v97, v85, v87, s44 bitop3:0x7e
    v_cndmask_b32 v97, 0, v97, s[46:47]
    v_or_b32 v96, v96, v97
    v_cmp_ne_u32 vcc, 0, v96
    s_sub_u32 s62, s62, 1
    s_nop 0
    s_cbranch_scc1 L_RH_out
    s_cbranch_vccnz L_RH
L_RH_out:
    v_add_f32_dpp v92, v92, v92 row_ror:8 row_mask:0xf bank_mask:0xf
    v_add_f32_dpp v93, v93, v93 row_ror:8 row_mask:0xf bank_mask:0xf
    v_cvt_pk_bf16_f32 v92, v92, v93
    v_lshlrev_b32 v28, 16, v92
    v_and_b32 v29, 0xffff0000, v92
    v_lshlrev_b32 v96, 16, v18
    v_and_b32 v97, 0xffff0000, v18
    v_pk_add_f32 v[28:29], v[28:29], v[96:97]
    v_cvt_pk_bf16_f32 v92, v28, v29
    v_lshlrev_b32 v28, 16, v92
    v_and_b32 v29, 0xffff0000, v92
    s_mov_b32 s62, 200000
L_RG0:
    buffer_load_dwordx4 v[52:55], v11, s[40:43], s56 offen sc1
    buffer_load_dwordx4 v[56:59], v11, s[40:43], s57 offen sc1
    s_sleep 6
L_RG:
    buffer_load_dwordx4 v[36:39], v11, s[40:43], s56 offen sc1
    buffer_load_dwordx4 v[40:43], v11, s[40:43], s57 offen sc1
    s_waitcnt vmcnt(2)
    v_mfma_f32_16x16x32_bf16 v[92:95], v[48:51], v[52:55], 0
    v_mfma_f32_16x16x32_bf16 v[92:95], v[48:51], v[56:59], v[92:95]
    v_bitop3_b32 v96, v53, v55, s44 bitop3:0x7e
    v_bitop3_b32 v97, v57, v59, s44 bitop3:0x7e
    v_or_b32 v96, v96, v97
    v_cmp_ne_u32 vcc, 0, v96
    s_nop 2
    s_cbranch_vccz L_RG_okA
    s_sub_u32 s62, s62, 1
    s_cbranch_scc1 L_RG_okA
    buffer_load_dwordx4 v[52:55], v11, s[40:43], s56 offen sc1
    buffer_load_dwordx4 v[56:59], v11, s[40:43], s57 offen sc1
    s_waitcnt vmcnt(2)
    v_mfma_f32_16x16x32_bf16 v[92:95], v[48:51], v[36:39], 0
    v_mfma_f32_16x16x32_bf16 v[92:95], v[48:51], v[40:43], v[92:95]
    v_bitop3_b32 v96, v37, v39, s44 bitop3:0x7e
    v_bitop3_b32 v97, v41, v43, s44 bitop3:0x7e
    v_or_b32 v96, v96, v97
    v_cmp_ne_u32 vcc, 0, v96
    s_nop 2
    s_cbranch_vccz L_RG_okB
    s_sub_u32 s62, s62, 1
    s_cbranch_scc0 L_RG
L_RG_okB:
L_RG_okA:
    v_add_f32_dpp v92, v92, v92 row_ror:8 row_mask:0xf bank_mask:0xf
    v_add_f32_dpp v93, v93, v93 row_ror:8 row_mask:0xf bank_mask:0xf
    s_mov_b64 exec, s[52:53]
    ds_write_b64 v27, v[92:93]
    s_mov_b64 exec, -1
    s_waitcnt lgkmcnt(0)
    s_barrier
    s_cmp_eq_u32 s3, 0
    s_cbranch_scc0 L_FIN
    v_add_u32 v1, 157056, v26
    ds_read_b64 v[64:65], v1 offset:0
    ds_read_b64 v[66:67], v1 offset:128
    ds_read_b64 v[68:69], v1 offset:256
    ds_read_b64 v[70:71], v1 offset:384
    ds_read_b64 v[72:73], v1 offset:512
    ds_read_b64 v[74:75], v1 offset:640
    ds_read_b64 v[76:77], v1 offset:768
    ds_read_b64 v[78:79], v1 offset:896
    ds_read_b64 v[80:81], v1 offset:1024
    s_waitcnt lgkmcnt(0)
    v_pk_add_f32 v[64:65], v[64:65], v[66:67]
    v_pk_add_f32 v[68:69], v[68:69], v[70:71]
    v_pk_add_f32 v[72:73], v[72:73], v[74:75]
    v_pk_add_f32 v[76:77], v[76:77], v[78:79]
    v_pk_add_f32 v[64:65], v[64:65], v[68:69]
    v_pk_add_f32 v[72:73], v[72:73], v[76:77]
    v_pk_add_f32 v[64:65], v[64:65], v[80:81]
    v_pk_add_f32 v[64:65], v[64:65], v[72:73]
    v_cvt_pk_bf16_f32 v64, v64, v65
    v_lshlrev_b32 v66, 16, v64
    v_and_b32 v67, 0xffff0000, v64
    v_pk_add_f32 v[66:67], v[66:67], v[28:29]
    v_cvt_pk_bf16_f32 v64, v66, v67
    s_mov_b64 exec, s[52:53]
    buffer_store_dword v64, v25, s[8:11], 0 offen
L_FIN0:
    s_mov_b64 exec, -1
L_FIN:
L_END:
    s_endpgm
.section .rodata,"a"
.p2align 6
.amdhsa_kernel sequential_preLN__sliding_block_cached__geglu_ffn__decode_kernel
  .amdhsa_next_free_vgpr 168
  .amdhsa_next_free_sgpr 102
  .amdhsa_accum_offset 168
  .amdhsa_group_segment_fixed_size 0
  .amdhsa_kernarg_size 96
  .amdhsa_user_sgpr_count 2
  .amdhsa_user_sgpr_kernarg_segment_ptr 1
  .amdhsa_system_sgpr_workgroup_id_x 1
  .amdhsa_float_denorm_mode_32 3
.end_amdhsa_kernel
```
